```python
import torch

def _softmax(x, axis=-1):
    return torch.softmax(x, dim=axis)
def _gelu(x):
    return torch.nn.functional.gelu(x, approximate="tanh")
def _silu(x):
    return torch.nn.functional.silu(x)
def _sigmoid(x):
    return torch.sigmoid(x)
def _layernorm(x, axis=-1, eps=1e-5):
    m = x.mean(dim=axis, keepdim=True)
    v = x.var(dim=axis, keepdim=True, unbiased=False)
    return (x - m) / torch.sqrt(v + eps)
def _scatter_add(tgt, idx, src, axis=0):
    return tgt.clone().index_add_(axis, idx, src)
def _segment_sum(src, seg, n):
    out = torch.zeros((n,) + src.shape[1:], dtype=src.dtype)
    return out.index_add_(0, seg, src)
def _pad(x, pw):
    flat = tuple(v for pair in reversed(pw) for v in pair)
    return torch.nn.functional.pad(x, flat)

kernel_name = 'recurrent_scan__compressed_kv_cla__dense_activation_gelu__decode'

def setup_inputs():

    _w = (lambda a: (lambda t: t.to(torch.bfloat16) if t.is_floating_point() else t)(torch.as_tensor(a)))
    def _A_setup():
        B, H, Sq, Sk, D, M = 2, 32, 1, 4096, 128, 512
        Dc = 4 * D
        return {
            "x": _w((lambda *s: torch.randn(*s, dtype=torch.bfloat16) * 0.1)(B, Sq, M)),
            "c_kv": _w((lambda *s: torch.randn(*s, dtype=torch.bfloat16) * 3.2)(B, Sk, Dc)),
            "w_q": _w((lambda *s: torch.randn(*s, dtype=torch.bfloat16) * 0.8)(M, H, D) * (M ** -0.5)),
            "w_uk": _w((lambda *s: torch.randn(*s, dtype=torch.bfloat16) * 0.8)(Dc, H, D) * (Dc ** -0.5)),
            "w_uv": _w((lambda *s: torch.randn(*s, dtype=torch.bfloat16) * 3.2)(Dc, H, D) * (Dc ** -0.5)),
            "w_o": _w((lambda *s: torch.randn(*s, dtype=torch.bfloat16) * 3.2)(H, D, M) * ((H * D) ** -0.5)),
        }
    _A_in = _A_setup()

    def _B_setup():
        B, S, D, F = 2, 1, 512, 1376
        return {
            "x": _w((lambda *s: torch.randn(*s, dtype=torch.bfloat16) * 0.1)(B, S, D)),
            "w1": _w((lambda *s: torch.randn(*s, dtype=torch.bfloat16) * 3.2)(D, F) * (D ** -0.5)),
            "b1": _w((lambda *s: torch.randn(*s, dtype=torch.bfloat16) * 3.2)(F) * 0.01),
            "w2": _w((lambda *s: torch.randn(*s, dtype=torch.bfloat16) * 3.2)(F, D) * (F ** -0.5)),
            "b2": _w((lambda *s: torch.randn(*s, dtype=torch.bfloat16) * 3.2)(D) * 0.01),
        }
    _B_in = _B_setup()

    return {
        "A_x": _A_in["x"],
        "A_c_kv": _A_in["c_kv"],
        "A_w_q": _A_in["w_q"],
        "A_w_uk": _A_in["w_uk"],
        "A_w_uv": _A_in["w_uv"],
        "A_w_o": _A_in["w_o"],
        "B_x": _B_in["x"],
        "B_w1": _B_in["w1"],
        "B_b1": _B_in["b1"],
        "B_w2": _B_in["w2"],
        "B_b2": _B_in["b2"],
    }

def reference(A_x, A_c_kv, A_w_q, A_w_uk, A_w_uv, A_w_o, B_x, B_w1, B_b1, B_w2, B_b2):
    def _A_ref(x, c_kv, w_q, w_uk, w_uv, w_o):
        B, Sq, M = x.shape[0], x.shape[1], x.shape[2]
        Sk = c_kv.shape[1]
        H, D = w_q.shape[1], w_q.shape[2]
        q = torch.einsum("bqm,mhd->bhqd", x, w_q)
        k = torch.einsum("bkc,chd->bhkd", c_kv, w_uk)
        v = torch.einsum("bkc,chd->bhkd", c_kv, w_uv)
        scores = torch.einsum("bhqd,bhkd->bhqk", q, k) * (D ** -0.5)
        off = Sk - Sq
        qi = torch.arange(Sq)[:, None]
        kj = torch.arange(Sk)[None, :]
        cmask = kj <= (qi + off)
        scores = torch.where(cmask[None, None], scores, -1e9)
        p = _softmax(scores, axis=-1)
        ctx = torch.einsum("bhqk,bhkd->bhqd", p, v)
        return torch.einsum("bhqd,hdm->bqm", ctx, w_o)

    def _B_ref(x, w1, b1, w2, b2):
        h = torch.einsum("bsd,df->bsf", x, w1) + b1
        h = _gelu(h)
        return torch.einsum("bsf,fd->bsd", h, w2) + b2

    x = A_x
    xn = _layernorm(x, axis=-1)
    s = _A_ref(xn, A_c_kv, A_w_q, A_w_uk, A_w_uv, A_w_o)
    g = _silu(_B_ref(xn, B_w1, B_b1, B_w2, B_b2))
    return x + s * g
```

```asm
; @launch grid=(256,1,1) block=(512,1,1) lds=163840
.amdgcn_target "amdgcn-amd-amdhsa--gfx950"
.text
.globl recurrent_scan__compressed_kv_cla__dense_activation_gelu__decode_kernel
.p2align 8
.type recurrent_scan__compressed_kv_cla__dense_activation_gelu__decode_kernel,@function
recurrent_scan__compressed_kv_cla__dense_activation_gelu__decode_kernel:
    s_cmp_ge_u32 s2, 256
    s_cbranch_scc1 END
    s_load_dwordx16 s[64:79], s[0:1], 0
    s_load_dwordx8 s[80:87], s[0:1], 64
    s_load_dwordx4 s[88:91], s[0:1], 96
    v_and_b32 v1, 63, v0
    v_lshrrev_b32 v12, 6, v0
    v_and_b32 v2, 15, v1
    v_lshrrev_b32 v3, 4, v1
    v_readfirstlane_b32 s62, v12
    s_lshl_b32 s62, s62, 2
    s_mov_b32 s3, 0x65321074
    s_lshr_b32 s62, s3, s62
    s_and_b32 s62, s62, 7
    s_lshl_b32 s3, s62, 6
    v_or_b32 v0, s3, v1
    s_and_b32 s4, s2, 7
    s_lshr_b32 s3, s2, 3
    s_lshr_b32 s56, s3, 3
    s_bfe_u32 s57, s3, 0x10002
    s_and_b32 s58, s3, 3
    s_lshl_b32 s59, s4, 2
    s_add_u32 s59, s59, s56
    s_xor_b32 s59, s59, 1
    s_lshl_b32 s60, s4, 3
    s_and_b32 s5, s3, 7
    s_add_u32 s60, s60, s5
    s_mul_i32 s5, s4, 22
    s_add_u32 s5, s5, s3
    s_lshr_b32 s61, s5, 3
    s_lshl_b32 s61, s61, 1
    s_and_b32 s6, s5, 1
    s_add_u32 s61, s61, s6
    s_bfe_u32 s94, s5, 0x20001
    s_cmp_lt_u32 s3, 22
    s_cselect_b32 s95, 1, 0
    s_cmp_lt_u32 s61, 43
    s_cselect_b32 s95, s95, 0
    v_mov_b32 v120, 0xf0000000
    v_mov_b32 v25, 0xf0000000
    v_mov_b32 v24, 156416
    v_mov_b32 v23, 1
    s_waitcnt lgkmcnt(0)
    s_mov_b32 s8, s64
    s_mov_b32 s9, s65
    s_mov_b32 s10, 2048
    s_mov_b32 s11, 0x00020000
    s_mov_b32 s12, s66
    s_mov_b32 s13, s67
    s_mov_b32 s14, 8388608
    s_mov_b32 s15, 0x00020000
    s_mov_b32 s16, s68
    s_mov_b32 s17, s69
    s_mov_b32 s18, 4194304
    s_mov_b32 s19, 0x00020000
    s_mov_b32 s20, s70
    s_mov_b32 s21, s71
    s_mov_b32 s22, 4194304
    s_mov_b32 s23, 0x00020000
    s_mov_b32 s24, s72
    s_mov_b32 s25, s73
    s_mov_b32 s26, 4194304
    s_mov_b32 s27, 0x00020000
    s_mov_b32 s28, s74
    s_mov_b32 s29, s75
    s_mov_b32 s30, 4194304
    s_mov_b32 s31, 0x00020000
    s_mov_b32 s32, s78
    s_mov_b32 s33, s79
    s_mov_b32 s34, 1409024
    s_mov_b32 s35, 0x00020000
    s_mov_b32 s36, s82
    s_mov_b32 s37, s83
    s_mov_b32 s38, 1409024
    s_mov_b32 s39, 0x00020000
    s_mov_b32 s40, s90
    s_mov_b32 s41, s91
    s_mov_b32 s42, 268435456
    s_mov_b32 s43, 0x00020000
    s_mov_b32 s44, s86
    s_mov_b32 s45, s87
    s_mov_b32 s46, 2048
    s_mov_b32 s47, 0x00020000
    s_mov_b32 s48, s80
    s_mov_b32 s49, s81
    s_mov_b32 s50, 2752
    s_mov_b32 s51, 0x00020000
    s_mov_b32 s52, s84
    s_mov_b32 s53, s85
    s_mov_b32 s54, 1024
    s_mov_b32 s55, 0x00020000
    s_lshl_b32 s7, s59, 8
    s_lshl_b32 s64, s57, 7
    s_add_u32 s7, s7, s64
    s_cmp_ge_u32 s62, 4
    s_cbranch_scc1 KPATH
    v_lshrrev_b32 v12, 3, v2
    v_lshlrev_b32 v12, 13, v12
    v_lshl_add_u32 v12, v3, 18, v12
    v_and_b32 v13, 7, v2
    v_lshl_add_u32 v31, v13, 4, v12
    s_lshl_b32 s68, s62, 20
    s_add_u32 s68, s68, s7
    s_add_u32 s64, s58, 0
    s_and_b32 s64, s64, 3
    s_lshl_b32 s64, s64, 16
    s_add_u32 s64, s64, s68
    buffer_load_dwordx4 v[160:163], v31, s[16:19], s64 offen
    s_add_u32 s64, s64, 16384
    buffer_load_dwordx4 v[164:167], v31, s[16:19], s64 offen
    s_add_u32 s64, s64, 16384
    buffer_load_dwordx4 v[168:171], v31, s[16:19], s64 offen
    s_add_u32 s64, s64, 16384
    buffer_load_dwordx4 v[172:175], v31, s[16:19], s64 offen
    v_lshlrev_b32 v27, 13, v2
    v_lshl_add_u32 v27, v3, 4, v27
    s_lshl_b32 s64, s58, 20
    s_lshl_b32 s65, s62, 18
    s_add_u32 s64, s64, s65
    s_add_u32 s64, s64, s7
    buffer_load_dwordx4 v[224:227], v27, s[20:23], s64 offen offset:0 nt
    buffer_load_dwordx4 v[228:231], v27, s[20:23], s64 offen offset:64 nt
    s_add_u32 s64, s64, 131072
    buffer_load_dwordx4 v[232:235], v27, s[20:23], s64 offen offset:0 nt
    buffer_load_dwordx4 v[236:239], v27, s[20:23], s64 offen offset:64 nt
    s_barrier
    s_add_u32 s64, s58, 1
    s_and_b32 s64, s64, 3
    s_lshl_b32 s64, s64, 16
    s_add_u32 s64, s64, s68
    buffer_load_dwordx4 v[176:179], v31, s[16:19], s64 offen
    s_add_u32 s64, s64, 16384
    buffer_load_dwordx4 v[180:183], v31, s[16:19], s64 offen
    s_add_u32 s64, s64, 16384
    buffer_load_dwordx4 v[184:187], v31, s[16:19], s64 offen
    s_add_u32 s64, s64, 16384
    buffer_load_dwordx4 v[188:191], v31, s[16:19], s64 offen
    v_and_b32 v12, 7, v2
    v_lshrrev_b32 v13, 1, v12
    v_and_b32 v14, 1, v12
    s_mov_b32 s64, 0x0c0c0100
    s_mov_b32 s65, 0x01000c0c
    s_mov_b32 s66, 0x0c0c0302
    s_mov_b32 s67, 0x03020c0c
    v_cmp_eq_u32 vcc, 1, v14
    v_mov_b32 v15, s64
    v_mov_b32 v16, s65
    v_mov_b32 v17, s66
    v_mov_b32 v18, s67
    v_cndmask_b32 v15, v15, v16, vcc
    v_cndmask_b32 v17, v17, v18, vcc
    v_mov_b32 v16, 0x0c0c0c0c
    v_cmp_eq_u32 vcc, 0, v13
    v_cndmask_b32 v4, v16, v15, vcc
    v_cndmask_b32 v8, v16, v17, vcc
    v_cmp_eq_u32 vcc, 1, v13
    v_cndmask_b32 v5, v16, v15, vcc
    v_cndmask_b32 v9, v16, v17, vcc
    v_cmp_eq_u32 vcc, 2, v13
    v_cndmask_b32 v6, v16, v15, vcc
    v_cndmask_b32 v10, v16, v17, vcc
    v_cmp_eq_u32 vcc, 3, v13
    v_cndmask_b32 v7, v16, v15, vcc
    v_cndmask_b32 v11, v16, v17, vcc
    v_and_b32 v12, 1, v2
    v_lshlrev_b32 v12, 17, v12
    v_lshrrev_b32 v13, 1, v2
    v_lshl_add_u32 v12, v13, 6, v12
    v_lshl_add_u32 v12, v3, 4, v12
    s_lshl_b32 s64, s7, 4
    s_lshl_b32 s65, s58, 9
    s_add_u32 s64, s64, s65
    s_lshl_b32 s65, s62, 7
    s_add_u32 s64, s64, s65
    s_add_u32 s64, s64, 3670016
    v_add_u32 v20, s64, v12
    v_cmp_gt_u32 vcc, 4, v2
    v_cndmask_b32 v20, v25, v20, vcc
    v_lshlrev_b32 v12, 16, v3
    v_lshl_add_u32 v12, v2, 4, v12
    s_lshl_b32 s64, s56, 19
    s_lshl_b32 s65, s62, 14
    s_add_u32 s64, s64, s65
    s_lshl_b32 s65, s60, 8
    s_add_u32 s64, s64, s65
    s_add_u32 s64, s64, 262144
    v_add_u32 v21, s64, v12
    s_lshl_b32 s64, s56, 12
    s_lshl_b32 s65, s60, 3
    s_add_u32 s64, s64, s65
    s_add_u32 s64, s64, 163840
    v_lshlrev_b32 v12, 9, v1
    v_add_u32 v22, s64, v12
    v_cmp_gt_u32 vcc, 8, v0
    v_cndmask_b32 v22, v25, v22, vcc
    v_lshrrev_b32 v12, 3, v2
    v_lshlrev_b32 v12, 10, v12
    v_lshl_add_u32 v12, v3, 6, v12
    s_lshl_b32 s64, s62, 8
    s_add_u32 s64, s64, 152064
    v_add_u32 v26, s64, v12
    v_lshrrev_b32 v12, 1, v3
    v_lshlrev_b32 v12, 8, v12
    v_and_b32 v13, 7, v2
    v_lshl_add_u32 v12, v13, 5, v12
    v_and_b32 v13, 1, v3
    v_lshl_add_u32 v12, v13, 4, v12
    s_lshl_b32 s64, s62, 9
    s_add_u32 s64, s64, 154112
    v_add_u32 v27, s64, v12
    v_lshlrev_b32 v28, 3, v1
    v_add_u32 v28, 154112, v28
    v_lshlrev_b32 v29, 2, v1
    v_add_u32 v29, 156160, v29
    v_and_b32 v30, 1, v2
    v_lshlrev_b32 v30, 7, v30
    v_lshl_add_u32 v30, v3, 4, v30
    v_add_u32 v30, 156160, v30
    s_add_u32 s64, s58, 0
    s_and_b32 s64, s64, 3
    s_lshl_b32 s64, s64, 4
    v_add_u32 v16, s64, v26
    s_add_u32 s64, s58, 1
    s_and_b32 s64, s64, 3
    s_lshl_b32 s64, s64, 4
    v_add_u32 v17, s64, v26
    s_add_u32 s64, s58, 2
    s_and_b32 s64, s64, 3
    s_lshl_b32 s64, s64, 4
    v_add_u32 v18, s64, v26
    s_add_u32 s64, s58, 3
    s_and_b32 s64, s64, 3
    s_lshl_b32 s64, s64, 4
    v_add_u32 v19, s64, v26
    s_mov_b32 s70, 0
LS0:
    ds_read_b32 v15, v24 offset:4
    ds_read_b128 v[240:243], v16
    ds_read_b128 v[244:247], v17
    ds_read_b128 v[248:251], v18
    ds_read_b128 v[252:255], v19
    s_waitcnt lgkmcnt(4)
    v_readfirstlane_b32 s69, v15
    s_add_u32 s70, s70, 1
    s_cmp_ge_u32 s69, 1
    s_cbranch_scc1 LSD0
    s_cmp_lt_u32 s70, 400000
    s_cbranch_scc1 LS0
LSD0:
    s_waitcnt lgkmcnt(3)
    v_perm_b32 v32, v240, v240, v4
    v_perm_b32 v33, v240, v240, v5
    v_perm_b32 v34, v240, v240, v6
    v_perm_b32 v35, v240, v240, v7
    v_perm_b32 v36, v240, v240, v8
    v_perm_b32 v37, v240, v240, v9
    v_perm_b32 v38, v240, v240, v10
    v_perm_b32 v39, v240, v240, v11
    s_add_u32 s64, s58, 2
    s_and_b32 s64, s64, 3
    s_lshl_b32 s64, s64, 16
    s_add_u32 s64, s64, s68
    buffer_load_dwordx4 v[192:195], v31, s[16:19], s64 offen
    s_add_u32 s64, s64, 16384
    s_waitcnt vmcnt(12)
    v_mfma_f32_16x16x32_bf16 v[128:131], v[32:35], v[160:163], 0
    v_mfma_f32_16x16x32_bf16 v[136:139], v[36:39], v[160:163], 0
    v_perm_b32 v40, v241, v241, v4
    v_perm_b32 v41, v241, v241, v5
    v_perm_b32 v42, v241, v241, v6
    v_perm_b32 v43, v241, v241, v7
    v_perm_b32 v44, v241, v241, v8
    v_perm_b32 v45, v241, v241, v9
    v_perm_b32 v46, v241, v241, v10
    v_perm_b32 v47, v241, v241, v11
    buffer_load_dwordx4 v[196:199], v31, s[16:19], s64 offen
    s_add_u32 s64, s64, 16384
    s_waitcnt vmcnt(12)
    v_mfma_f32_16x16x32_bf16 v[132:135], v[40:43], v[164:167], 0
    v_mfma_f32_16x16x32_bf16 v[140:143], v[44:47], v[164:167], 0
    v_perm_b32 v48, v242, v242, v4
    v_perm_b32 v49, v242, v242, v5
    v_perm_b32 v50, v242, v242, v6
    v_perm_b32 v51, v242, v242, v7
    v_perm_b32 v52, v242, v242, v8
    v_perm_b32 v53, v242, v242, v9
    v_perm_b32 v54, v242, v242, v10
    v_perm_b32 v55, v242, v242, v11
    buffer_load_dwordx4 v[200:203], v31, s[16:19], s64 offen
    s_add_u32 s64, s64, 16384
    s_waitcnt vmcnt(12)
    v_mfma_f32_16x16x32_bf16 v[128:131], v[48:51], v[168:171], v[128:131]
    v_mfma_f32_16x16x32_bf16 v[136:139], v[52:55], v[168:171], v[136:139]
    v_perm_b32 v56, v243, v243, v4
    v_perm_b32 v57, v243, v243, v5
    v_perm_b32 v58, v243, v243, v6
    v_perm_b32 v59, v243, v243, v7
    v_perm_b32 v60, v243, v243, v8
    v_perm_b32 v61, v243, v243, v9
    v_perm_b32 v62, v243, v243, v10
    v_perm_b32 v63, v243, v243, v11
    buffer_load_dwordx4 v[204:207], v31, s[16:19], s64 offen
    s_waitcnt vmcnt(12)
    v_mfma_f32_16x16x32_bf16 v[132:135], v[56:59], v[172:175], v[132:135]
    v_mfma_f32_16x16x32_bf16 v[140:143], v[60:63], v[172:175], v[140:143]
    s_waitcnt lgkmcnt(2)
    v_perm_b32 v32, v244, v244, v4
    v_perm_b32 v33, v244, v244, v5
    v_perm_b32 v34, v244, v244, v6
    v_perm_b32 v35, v244, v244, v7
    v_perm_b32 v36, v244, v244, v8
    v_perm_b32 v37, v244, v244, v9
    v_perm_b32 v38, v244, v244, v10
    v_perm_b32 v39, v244, v244, v11
    s_add_u32 s64, s58, 3
    s_and_b32 s64, s64, 3
    s_lshl_b32 s64, s64, 16
    s_add_u32 s64, s64, s68
    buffer_load_dwordx4 v[208:211], v31, s[16:19], s64 offen
    s_add_u32 s64, s64, 16384
    s_waitcnt vmcnt(8)
    v_mfma_f32_16x16x32_bf16 v[128:131], v[32:35], v[176:179], v[128:131]
    v_mfma_f32_16x16x32_bf16 v[136:139], v[36:39], v[176:179], v[136:139]
    v_perm_b32 v40, v245, v245, v4
    v_perm_b32 v41, v245, v245, v5
    v_perm_b32 v42, v245, v245, v6
    v_perm_b32 v43, v245, v245, v7
    v_perm_b32 v44, v245, v245, v8
    v_perm_b32 v45, v245, v245, v9
    v_perm_b32 v46, v245, v245, v10
    v_perm_b32 v47, v245, v245, v11
    buffer_load_dwordx4 v[212:215], v31, s[16:19], s64 offen
    s_add_u32 s64, s64, 16384
    s_waitcnt vmcnt(8)
    v_mfma_f32_16x16x32_bf16 v[132:135], v[40:43], v[180:183], v[132:135]
    v_mfma_f32_16x16x32_bf16 v[140:143], v[44:47], v[180:183], v[140:143]
    v_perm_b32 v48, v246, v246, v4
    v_perm_b32 v49, v246, v246, v5
    v_perm_b32 v50, v246, v246, v6
    v_perm_b32 v51, v246, v246, v7
    v_perm_b32 v52, v246, v246, v8
    v_perm_b32 v53, v246, v246, v9
    v_perm_b32 v54, v246, v246, v10
    v_perm_b32 v55, v246, v246, v11
    buffer_load_dwordx4 v[216:219], v31, s[16:19], s64 offen
    s_add_u32 s64, s64, 16384
    s_waitcnt vmcnt(8)
    v_mfma_f32_16x16x32_bf16 v[128:131], v[48:51], v[184:187], v[128:131]
    v_mfma_f32_16x16x32_bf16 v[136:139], v[52:55], v[184:187], v[136:139]
    v_perm_b32 v56, v247, v247, v4
    v_perm_b32 v57, v247, v247, v5
    v_perm_b32 v58, v247, v247, v6
    v_perm_b32 v59, v247, v247, v7
    v_perm_b32 v60, v247, v247, v8
    v_perm_b32 v61, v247, v247, v9
    v_perm_b32 v62, v247, v247, v10
    v_perm_b32 v63, v247, v247, v11
    buffer_load_dwordx4 v[220:223], v31, s[16:19], s64 offen
    s_mov_b64 exec, 1
    ds_add_u32 v24, v23 offset:28
    s_mov_b64 exec, -1
    s_waitcnt vmcnt(8)
    v_mfma_f32_16x16x32_bf16 v[132:135], v[56:59], v[188:191], v[132:135]
    v_mfma_f32_16x16x32_bf16 v[140:143], v[60:63], v[188:191], v[140:143]
    s_waitcnt lgkmcnt(2)
    v_perm_b32 v32, v248, v248, v4
    v_perm_b32 v33, v248, v248, v5
    v_perm_b32 v34, v248, v248, v6
    v_perm_b32 v35, v248, v248, v7
    v_perm_b32 v36, v248, v248, v8
    v_perm_b32 v37, v248, v248, v9
    v_perm_b32 v38, v248, v248, v10
    v_perm_b32 v39, v248, v248, v11
    s_waitcnt vmcnt(7)
    v_mfma_f32_16x16x32_bf16 v[128:131], v[32:35], v[192:195], v[128:131]
    v_mfma_f32_16x16x32_bf16 v[136:139], v[36:39], v[192:195], v[136:139]
    v_perm_b32 v40, v249, v249, v4
    v_perm_b32 v41, v249, v249, v5
    v_perm_b32 v42, v249, v249, v6
    v_perm_b32 v43, v249, v249, v7
    v_perm_b32 v44, v249, v249, v8
    v_perm_b32 v45, v249, v249, v9
    v_perm_b32 v46, v249, v249, v10
    v_perm_b32 v47, v249, v249, v11
    s_waitcnt vmcnt(6)
    v_mfma_f32_16x16x32_bf16 v[132:135], v[40:43], v[196:199], v[132:135]
    v_mfma_f32_16x16x32_bf16 v[140:143], v[44:47], v[196:199], v[140:143]
    v_perm_b32 v48, v250, v250, v4
    v_perm_b32 v49, v250, v250, v5
    v_perm_b32 v50, v250, v250, v6
    v_perm_b32 v51, v250, v250, v7
    v_perm_b32 v52, v250, v250, v8
    v_perm_b32 v53, v250, v250, v9
    v_perm_b32 v54, v250, v250, v10
    v_perm_b32 v55, v250, v250, v11
    s_waitcnt vmcnt(5)
    v_mfma_f32_16x16x32_bf16 v[128:131], v[48:51], v[200:203], v[128:131]
    v_mfma_f32_16x16x32_bf16 v[136:139], v[52:55], v[200:203], v[136:139]
    v_perm_b32 v56, v251, v251, v4
    v_perm_b32 v57, v251, v251, v5
    v_perm_b32 v58, v251, v251, v6
    v_perm_b32 v59, v251, v251, v7
    v_perm_b32 v60, v251, v251, v8
    v_perm_b32 v61, v251, v251, v9
    v_perm_b32 v62, v251, v251, v10
    v_perm_b32 v63, v251, v251, v11
    s_waitcnt vmcnt(4)
    v_mfma_f32_16x16x32_bf16 v[132:135], v[56:59], v[204:207], v[132:135]
    v_mfma_f32_16x16x32_bf16 v[140:143], v[60:63], v[204:207], v[140:143]
    s_waitcnt lgkmcnt(1)
    v_perm_b32 v32, v252, v252, v4
    v_perm_b32 v33, v252, v252, v5
    v_perm_b32 v34, v252, v252, v6
    v_perm_b32 v35, v252, v252, v7
    v_perm_b32 v36, v252, v252, v8
    v_perm_b32 v37, v252, v252, v9
    v_perm_b32 v38, v252, v252, v10
    v_perm_b32 v39, v252, v252, v11
    s_waitcnt vmcnt(3)
    v_mfma_f32_16x16x32_bf16 v[128:131], v[32:35], v[208:211], v[128:131]
    v_mfma_f32_16x16x32_bf16 v[136:139], v[36:39], v[208:211], v[136:139]
    v_perm_b32 v40, v253, v253, v4
    v_perm_b32 v41, v253, v253, v5
    v_perm_b32 v42, v253, v253, v6
    v_perm_b32 v43, v253, v253, v7
    v_perm_b32 v44, v253, v253, v8
    v_perm_b32 v45, v253, v253, v9
    v_perm_b32 v46, v253, v253, v10
    v_perm_b32 v47, v253, v253, v11
    s_waitcnt vmcnt(2)
    v_mfma_f32_16x16x32_bf16 v[132:135], v[40:43], v[212:215], v[132:135]
    v_mfma_f32_16x16x32_bf16 v[140:143], v[44:47], v[212:215], v[140:143]
    v_perm_b32 v48, v254, v254, v4
    v_perm_b32 v49, v254, v254, v5
    v_perm_b32 v50, v254, v254, v6
    v_perm_b32 v51, v254, v254, v7
    v_perm_b32 v52, v254, v254, v8
    v_perm_b32 v53, v254, v254, v9
    v_perm_b32 v54, v254, v254, v10
    v_perm_b32 v55, v254, v254, v11
    s_waitcnt vmcnt(1)
    v_mfma_f32_16x16x32_bf16 v[128:131], v[48:51], v[216:219], v[128:131]
    v_mfma_f32_16x16x32_bf16 v[136:139], v[52:55], v[216:219], v[136:139]
    v_perm_b32 v56, v255, v255, v4
    v_perm_b32 v57, v255, v255, v5
    v_perm_b32 v58, v255, v255, v6
    v_perm_b32 v59, v255, v255, v7
    v_perm_b32 v60, v255, v255, v8
    v_perm_b32 v61, v255, v255, v9
    v_perm_b32 v62, v255, v255, v10
    v_perm_b32 v63, v255, v255, v11
    s_waitcnt vmcnt(0)
    v_mfma_f32_16x16x32_bf16 v[132:135], v[56:59], v[220:223], v[132:135]
    v_mfma_f32_16x16x32_bf16 v[140:143], v[60:63], v[220:223], v[140:143]
    v_cmp_gt_u32 vcc, 8, v2
    s_nop 7
    v_add_f32 v128, v128, v132
    v_add_f32 v136, v136, v140
    v_add_f32 v129, v129, v133
    v_add_f32 v137, v137, v141
    v_add_f32 v130, v130, v134
    v_add_f32 v138, v138, v142
    v_add_f32 v131, v131, v135
    v_add_f32 v139, v139, v143
    v_cndmask_b32 v128, v136, v128, vcc
    v_cndmask_b32 v129, v137, v129, vcc
    v_cndmask_b32 v130, v138, v130, vcc
    v_cndmask_b32 v131, v139, v131, vcc
    s_nop 1
    v_add_f32_dpp v128, v128, v128 row_ror:8 row_mask:0xf bank_mask:0xf
    v_add_f32_dpp v129, v129, v129 row_ror:8 row_mask:0xf bank_mask:0xf
    v_add_f32_dpp v130, v130, v130 row_ror:8 row_mask:0xf bank_mask:0xf
    v_add_f32_dpp v131, v131, v131 row_ror:8 row_mask:0xf bank_mask:0xf
    ds_write_b128 v27, v[128:131]
    s_mov_b64 exec, 1
    ds_add_u32 v24, v23 offset:0
    s_mov_b64 exec, -1
    s_mov_b32 s70, 0
LS1:
    ds_read_b32 v31, v24 offset:0
    ds_read_b64 v[32:33], v28 offset:0
    ds_read_b64 v[34:35], v28 offset:512
    ds_read_b64 v[36:37], v28 offset:1024
    ds_read_b64 v[38:39], v28 offset:1536
    ds_read_b32 v14, v24 offset:40
    s_waitcnt lgkmcnt(5)
    v_readfirstlane_b32 s69, v31
    s_add_u32 s70, s70, 1
    s_cmp_ge_u32 s69, 6
    s_cbranch_scc1 LSD1
    s_cmp_lt_u32 s70, 400000
    s_cbranch_scc1 LS1
LSD1:
    s_waitcnt lgkmcnt(0)
    v_readfirstlane_b32 s63, v14
    v_mov_b32 v15, v14
    v_add_f32 v32, v32, v34
    v_add_f32 v36, v36, v38
    v_add_f32 v33, v33, v35
    v_add_f32 v37, v37, v39
    v_add_f32 v32, v32, v36
    v_add_f32 v33, v33, v37
    v_cvt_pk_bf16_f32 v32, v32, v33
    ds_write_b32 v29, v32
    ds_read_b128 v[36:39], v30
    ds_read_b128 v[40:43], v30 offset:64
    v_lshrrev_b32 v12, 1, v2
    v_cmp_eq_u32 vcc, 1, v12
    s_waitcnt vmcnt(0) lgkmcnt(1)
    v_mfma_f32_16x16x32_bf16 v[44:47], v[224:227], v[36:39], 0
    v_mfma_f32_16x16x32_bf16 v[48:51], v[232:235], v[36:39], 0
    s_waitcnt lgkmcnt(0)
    v_mfma_f32_16x16x32_bf16 v[44:47], v[228:231], v[40:43], v[44:47]
    v_mfma_f32_16x16x32_bf16 v[48:51], v[236:239], v[40:43], v[48:51]
    s_nop 7
    s_nop 1
    v_cndmask_b32 v44, v44, v48, vcc
    v_cndmask_b32 v45, v45, v49, vcc
    v_cndmask_b32 v46, v46, v50, vcc
    v_cndmask_b32 v47, v47, v51, vcc
    v_cvt_pk_bf16_f32 v12, v44, v45
    v_cvt_pk_bf16_f32 v13, v46, v47
    buffer_store_dwordx4 v[12:15], v20, s[40:43], 0 offen sc1
    s_lshr_b32 s64, s60, 5
    s_lshl_b32 s64, s64, 17
    s_lshl_b32 s65, s56, 15
    s_add_u32 s64, s64, s65
    s_lshl_b32 s65, s62, 13
    s_add_u32 s64, s64, s65
    s_add_u32 s64, s64, 3670016
    v_lshlrev_b32 v31, 4, v1
    v_add_u32 v26, s64, v31
    v_lshlrev_b32 v31, 3, v1
    s_mul_i32 s64, s62, 2112
    s_add_u32 s64, s64, 135168
    v_add_u32 v27, s64, v31
    v_mul_u32_u24 v12, 1056, v2
    v_lshl_add_u32 v12, v3, 4, v12
    s_mul_i32 s64, s62, 33792
    v_add_u32 v28, s64, v12
    v_add_u32 v20, 135168, v12
    v_lshrrev_b32 v12, 2, v2
    v_lshl_add_u32 v12, v3, 2, v12
    v_mul_u32_u24 v12, 1056, v12
    v_and_b32 v13, 3, v2
    v_lshl_add_u32 v12, v13, 3, v12
    s_lshl_b32 s64, s62, 8
    v_add_u32 v29, s64, v12
    v_add_u32 v30, 67584, v29
    s_movk_i32 s65, 4096
    s_mov_b32 s70, 0
LS2:
    ds_read_b32 v15, v24 offset:32
    s_waitcnt lgkmcnt(0)
    v_readfirstlane_b32 s69, v15
    s_add_u32 s70, s70, 1
    s_cmp_ge_u32 s69, 3
    s_cbranch_scc1 LSD2
    s_cmp_lt_u32 s70, 400000
    s_cbranch_scc1 LS2
LSD2:
    s_mov_b32 s70, 0
    buffer_load_dwordx4 v[160:163], v26, s[40:43], 0 offen offset:0 sc1
    buffer_load_dwordx4 v[164:167], v26, s[40:43], 0 offen offset:1024 sc1
    buffer_load_dwordx4 v[168:171], v26, s[40:43], 0 offen offset:2048 sc1
    buffer_load_dwordx4 v[172:175], v26, s[40:43], 0 offen offset:3072 sc1
    buffer_load_dwordx4 v[176:179], v26, s[40:43], s65 offen offset:0 sc1
    buffer_load_dwordx4 v[180:183], v26, s[40:43], s65 offen offset:1024 sc1
    buffer_load_dwordx4 v[184:187], v26, s[40:43], s65 offen offset:2048 sc1
    buffer_load_dwordx4 v[188:191], v26, s[40:43], s65 offen offset:3072 sc1
    s_mov_b32 s70, 0
LS4:
    ds_read_b32 v15, v24 offset:8
    s_waitcnt lgkmcnt(0)
    v_readfirstlane_b32 s69, v15
    s_add_u32 s70, s70, 1
    s_cmp_ge_u32 s69, 3
    s_cbranch_scc1 LSD4
    s_cmp_lt_u32 s70, 400000
    s_cbranch_scc1 LS4
LSD4:
    s_mov_b32 s70, 0
    ds_read_b128 v[32:35], v28 offset:0
    ds_read_b128 v[36:39], v28 offset:64
    ds_read_b128 v[40:43], v28 offset:128
    ds_read_b128 v[44:47], v28 offset:192
    ds_read_b128 v[48:51], v28 offset:256
    ds_read_b128 v[52:55], v28 offset:320
    ds_read_b128 v[56:59], v28 offset:384
    ds_read_b128 v[60:63], v28 offset:448
    s_waitcnt lgkmcnt(6)
    ds_read_b128 v[64:67], v28 offset:512
    ds_read_b128 v[68:71], v28 offset:576
    ds_read_b128 v[72:75], v28 offset:640
    ds_read_b128 v[76:79], v28 offset:704
    ds_read_b128 v[80:83], v28 offset:768
    ds_read_b128 v[84:87], v28 offset:832
    ds_read_b128 v[88:91], v28 offset:896
    ds_read_b128 v[92:95], v28 offset:960
    s_waitcnt lgkmcnt(6)
    ds_read_b128 v[96:99], v28 offset:16896
    ds_read_b128 v[100:103], v28 offset:16960
    ds_read_b128 v[104:107], v28 offset:17024
    ds_read_b128 v[108:111], v28 offset:17088
    ds_read_b128 v[112:115], v28 offset:17152
    ds_read_b128 v[116:119], v28 offset:17216
    ds_read_b128 v[120:123], v28 offset:17280
    ds_read_b128 v[124:127], v28 offset:17344
    s_waitcnt lgkmcnt(6)
    ds_read_b128 v[128:131], v28 offset:17408
    ds_read_b128 v[132:135], v28 offset:17472
    ds_read_b128 v[136:139], v28 offset:17536
    ds_read_b128 v[140:143], v28 offset:17600
    ds_read_b128 v[144:147], v28 offset:17664
    ds_read_b128 v[148:151], v28 offset:17728
    ds_read_b128 v[152:155], v28 offset:17792
    ds_read_b128 v[156:159], v28 offset:17856
    s_waitcnt lgkmcnt(6)
    ds_read_b64_tr_b16 v[224:225], v29 offset:0
    ds_read_b64_tr_b16 v[226:227], v29 offset:16896
    ds_read_b64_tr_b16 v[228:229], v29 offset:32
    ds_read_b64_tr_b16 v[230:231], v29 offset:16928
    ds_read_b64_tr_b16 v[232:233], v29 offset:64
    ds_read_b64_tr_b16 v[234:235], v29 offset:16960
    ds_read_b64_tr_b16 v[236:237], v29 offset:96
    ds_read_b64_tr_b16 v[238:239], v29 offset:16992
    s_waitcnt lgkmcnt(6)
    ds_read_b64_tr_b16 v[240:241], v29 offset:128
    ds_read_b64_tr_b16 v[242:243], v29 offset:17024
    ds_read_b64_tr_b16 v[244:245], v29 offset:160
    ds_read_b64_tr_b16 v[246:247], v29 offset:17056
    ds_read_b64_tr_b16 v[248:249], v29 offset:192
    ds_read_b64_tr_b16 v[250:251], v29 offset:17088
    ds_read_b64_tr_b16 v[252:253], v29 offset:224
    ds_read_b64_tr_b16 v[254:255], v29 offset:17120
    s_waitcnt lgkmcnt(6)
    s_branch POLLW3
POLL3:
    buffer_load_dwordx4 v[160:163], v26, s[40:43], 0 offen offset:0 sc1
    buffer_load_dwordx4 v[164:167], v26, s[40:43], 0 offen offset:1024 sc1
    buffer_load_dwordx4 v[168:171], v26, s[40:43], 0 offen offset:2048 sc1
    buffer_load_dwordx4 v[172:175], v26, s[40:43], 0 offen offset:3072 sc1
    buffer_load_dwordx4 v[176:179], v26, s[40:43], s65 offen offset:0 sc1
    buffer_load_dwordx4 v[180:183], v26, s[40:43], s65 offen offset:1024 sc1
    buffer_load_dwordx4 v[184:187], v26, s[40:43], s65 offen offset:2048 sc1
    buffer_load_dwordx4 v[188:191], v26, s[40:43], s65 offen offset:3072 sc1
POLLW3:
    s_waitcnt vmcnt(0)
POLLX3:
    v_max_u32 v14, v162, v163
    v_min_u32 v13, v162, v163
    v_max3_u32 v14, v14, v166, v167
    v_min3_u32 v13, v13, v166, v167
    v_max3_u32 v14, v14, v170, v171
    v_min3_u32 v13, v13, v170, v171
    v_max3_u32 v14, v14, v174, v175
    v_min3_u32 v13, v13, v174, v175
    v_max3_u32 v14, v14, v178, v179
    v_min3_u32 v13, v13, v178, v179
    v_max3_u32 v14, v14, v182, v183
    v_min3_u32 v13, v13, v182, v183
    v_max3_u32 v14, v14, v186, v187
    v_min3_u32 v13, v13, v186, v187
    v_max3_u32 v14, v14, v190, v191
    v_min3_u32 v13, v13, v190, v191
    v_xor_b32 v14, s63, v14
    v_xor_b32 v13, s63, v13
    v_or_b32 v14, v14, v13
    v_cmp_ne_u32 vcc, 0, v14
    s_add_u32 s70, s70, 1
    s_cbranch_vccz POLLD3
    s_mov_b64 exec, vcc
    s_cmp_lt_u32 s70, 400000
    s_cbranch_scc1 POLL3
POLLD3:
    s_mov_b64 exec, -1
    ds_write_b64 v27, v[160:161] offset:0
    ds_write_b64 v27, v[164:165] offset:512
    ds_write_b64 v27, v[168:169] offset:8448
    ds_write_b64 v27, v[172:173] offset:8960
    ds_write_b64 v27, v[176:177] offset:1056
    ds_write_b64 v27, v[180:181] offset:1568
    ds_write_b64 v27, v[184:185] offset:9504
    ds_write_b64 v27, v[188:189] offset:10016
    s_mov_b64 exec, 1
    ds_add_u32 v24, v23 offset:16
    s_mov_b64 exec, -1
    s_waitcnt lgkmcnt(6)
    s_mov_b32 s70, 0
LS5:
    ds_read_b32 v31, v24 offset:16
    ds_read_b128 v[160:163], v20 offset:0
    ds_read_b128 v[164:167], v20 offset:64
    ds_read_b128 v[168:171], v20 offset:128
    ds_read_b128 v[172:175], v20 offset:192
    ds_read_b128 v[176:179], v20 offset:256
    ds_read_b128 v[180:183], v20 offset:320
    ds_read_b128 v[184:187], v20 offset:384
    ds_read_b128 v[188:191], v20 offset:448
    s_waitcnt lgkmcnt(8)
    v_readfirstlane_b32 s69, v31
    s_add_u32 s70, s70, 1
    s_cmp_ge_u32 s69, 4
    s_cbranch_scc1 LSD5
    s_cmp_lt_u32 s70, 400000
    s_cbranch_scc1 LS5
LSD5:
    ds_read_b128 v[192:195], v20 offset:512
    ds_read_b128 v[196:199], v20 offset:576
    ds_read_b128 v[200:203], v20 offset:640
    ds_read_b128 v[204:207], v20 offset:704
    ds_read_b128 v[208:211], v20 offset:768
    ds_read_b128 v[212:215], v20 offset:832
    ds_read_b128 v[216:219], v20 offset:896
    s_waitcnt lgkmcnt(14)
    v_mfma_f32_16x16x32_bf16 v[4:7], v[32:35], v[160:163], 0
    v_mfma_f32_16x16x32_bf16 v[12:15], v[96:99], v[160:163], 0
    ds_read_b128 v[220:223], v20 offset:960
    s_waitcnt lgkmcnt(14)
    v_mfma_f32_16x16x32_bf16 v[8:11], v[36:39], v[164:167], 0
    v_mfma_f32_16x16x32_bf16 v[16:19], v[100:103], v[164:167], 0
    s_waitcnt lgkmcnt(13)
    v_mfma_f32_16x16x32_bf16 v[4:7], v[40:43], v[168:171], v[4:7]
    v_mfma_f32_16x16x32_bf16 v[12:15], v[104:107], v[168:171], v[12:15]
    s_waitcnt lgkmcnt(12)
    v_mfma_f32_16x16x32_bf16 v[8:11], v[44:47], v[172:175], v[8:11]
    v_mfma_f32_16x16x32_bf16 v[16:19], v[108:111], v[172:175], v[16:19]
    s_waitcnt lgkmcnt(11)
    v_mfma_f32_16x16x32_bf16 v[4:7], v[48:51], v[176:179], v[4:7]
    v_mfma_f32_16x16x32_bf16 v[12:15], v[112:115], v[176:179], v[12:15]
    s_waitcnt lgkmcnt(10)
    v_mfma_f32_16x16x32_bf16 v[8:11], v[52:55], v[180:183], v[8:11]
    v_mfma_f32_16x16x32_bf16 v[16:19], v[116:119], v[180:183], v[16:19]
    s_waitcnt lgkmcnt(9)
    v_mfma_f32_16x16x32_bf16 v[4:7], v[56:59], v[184:187], v[4:7]
    v_mfma_f32_16x16x32_bf16 v[12:15], v[120:123], v[184:187], v[12:15]
    s_waitcnt lgkmcnt(8)
    v_mfma_f32_16x16x32_bf16 v[8:11], v[60:63], v[188:191], v[8:11]
    v_mfma_f32_16x16x32_bf16 v[16:19], v[124:127], v[188:191], v[16:19]
    s_waitcnt lgkmcnt(7)
    v_mfma_f32_16x16x32_bf16 v[4:7], v[64:67], v[192:195], v[4:7]
    v_mfma_f32_16x16x32_bf16 v[12:15], v[128:131], v[192:195], v[12:15]
    s_waitcnt lgkmcnt(6)
    v_mfma_f32_16x16x32_bf16 v[8:11], v[68:71], v[196:199], v[8:11]
    v_mfma_f32_16x16x32_bf16 v[16:19], v[132:135], v[196:199], v[16:19]
    s_waitcnt lgkmcnt(5)
    v_mfma_f32_16x16x32_bf16 v[4:7], v[72:75], v[200:203], v[4:7]
    v_mfma_f32_16x16x32_bf16 v[12:15], v[136:139], v[200:203], v[12:15]
    s_waitcnt lgkmcnt(4)
    v_mfma_f32_16x16x32_bf16 v[8:11], v[76:79], v[204:207], v[8:11]
    v_mfma_f32_16x16x32_bf16 v[16:19], v[140:143], v[204:207], v[16:19]
    s_waitcnt lgkmcnt(3)
    v_mfma_f32_16x16x32_bf16 v[4:7], v[80:83], v[208:211], v[4:7]
    v_mfma_f32_16x16x32_bf16 v[12:15], v[144:147], v[208:211], v[12:15]
    s_waitcnt lgkmcnt(2)
    v_mfma_f32_16x16x32_bf16 v[8:11], v[84:87], v[212:215], v[8:11]
    v_mfma_f32_16x16x32_bf16 v[16:19], v[148:151], v[212:215], v[16:19]
    s_waitcnt lgkmcnt(1)
    v_mfma_f32_16x16x32_bf16 v[4:7], v[88:91], v[216:219], v[4:7]
    v_mfma_f32_16x16x32_bf16 v[12:15], v[152:155], v[216:219], v[12:15]
    s_waitcnt lgkmcnt(0)
    v_mfma_f32_16x16x32_bf16 v[8:11], v[92:95], v[220:223], v[8:11]
    v_mfma_f32_16x16x32_bf16 v[16:19], v[156:159], v[220:223], v[16:19]
    v_and_b32 v31, 7, v2
    v_lshlrev_b32 v26, 4, v31
    v_add_u32 v26, 156480, v26
    s_lshl_b32 s64, s62, 2
    v_add_u32 v27, s64, v26
    v_mul_u32_u24 v20, 288, v31
    v_lshl_add_u32 v20, v3, 4, v20
    v_add_u32 v20, 156736, v20
    v_lshrrev_b32 v31, 3, v2
    v_lshl_add_u32 v28, v31, 3, v20
    s_lshl_b32 s64, s62, 6
    v_add_u32 v28, s64, v28
    v_cmp_gt_u32 vcc, 8, v2
    s_nop 0
    v_add_f32 v4, v4, v8
    v_add_f32 v12, v12, v16
    v_add_f32 v5, v5, v9
    v_add_f32 v13, v13, v17
    v_add_f32 v6, v6, v10
    v_add_f32 v14, v14, v18
    v_add_f32 v7, v7, v11
    v_add_f32 v15, v15, v19
    s_nop 1
    v_add_f32_dpp v4, v4, v4 row_ror:8 row_mask:0xf bank_mask:0xf
    v_add_f32_dpp v5, v5, v5 row_ror:8 row_mask:0xf bank_mask:0xf
    v_add_f32_dpp v6, v6, v6 row_ror:8 row_mask:0xf bank_mask:0xf
    v_add_f32_dpp v7, v7, v7 row_ror:8 row_mask:0xf bank_mask:0xf
    v_add_f32_dpp v12, v12, v12 row_ror:8 row_mask:0xf bank_mask:0xf
    v_add_f32_dpp v13, v13, v13 row_ror:8 row_mask:0xf bank_mask:0xf
    v_add_f32_dpp v14, v14, v14 row_ror:8 row_mask:0xf bank_mask:0xf
    v_add_f32_dpp v15, v15, v15 row_ror:8 row_mask:0xf bank_mask:0xf
    v_cndmask_b32 v4, v12, v4, vcc
    v_cndmask_b32 v5, v13, v5, vcc
    v_cndmask_b32 v6, v14, v6, vcc
    v_cndmask_b32 v7, v15, v7, vcc
    v_cvt_pk_bf16_f32 v12, v4, v5
    v_lshlrev_b32 v4, 16, v12
    v_and_b32 v5, 0xffff0000, v12
    v_cvt_pk_bf16_f32 v13, v6, v7
    v_lshlrev_b32 v6, 16, v13
    v_and_b32 v7, 0xffff0000, v13
    v_mul_f32 v4, 0x3db504f3, v4
    v_mul_f32 v5, 0x3db504f3, v5
    v_mul_f32 v6, 0x3db504f3, v6
    v_mul_f32 v7, 0x3db504f3, v7
    v_cvt_pk_bf16_f32 v12, v4, v5
    v_lshlrev_b32 v4, 16, v12
    v_and_b32 v5, 0xffff0000, v12
    v_cvt_pk_bf16_f32 v13, v6, v7
    v_lshlrev_b32 v6, 16, v13
    v_and_b32 v7, 0xffff0000, v13
    v_max3_f32 v8, v4, v5, v6
    v_max_f32 v8, v8, v7
    s_nop 1
    v_max_f32_dpp v8, v8, v8 row_ror:8 row_mask:0xf bank_mask:0xf
    v_mov_b32 v9, v8
    s_nop 1
    v_permlane16_swap_b32 v8, v9
    s_nop 1
    v_max_f32 v8, v8, v9
    v_mov_b32 v9, v8
    s_nop 1
    v_permlane32_swap_b32 v8, v9
    s_nop 1
    v_max_f32 v8, v8, v9
    s_mov_b64 exec, 0xff
    ds_write_b32 v27, v8
    s_mov_b64 exec, -1
    s_mov_b64 exec, 1
    ds_add_u32 v24, v23 offset:20
    s_mov_b64 exec, -1
    ds_read_b64_tr_b16 v[32:33], v29 offset:33792
    ds_read_b64_tr_b16 v[34:35], v29 offset:50688
    ds_read_b64_tr_b16 v[36:37], v29 offset:33824
    ds_read_b64_tr_b16 v[38:39], v29 offset:50720
    ds_read_b64_tr_b16 v[40:41], v29 offset:33856
    ds_read_b64_tr_b16 v[42:43], v29 offset:50752
    ds_read_b64_tr_b16 v[44:45], v29 offset:33888
    ds_read_b64_tr_b16 v[46:47], v29 offset:50784
    ds_read_b64_tr_b16 v[48:49], v29 offset:33920
    ds_read_b64_tr_b16 v[50:51], v29 offset:50816
    s_waitcnt lgkmcnt(4)
    ds_read_b64_tr_b16 v[52:53], v29 offset:33952
    ds_read_b64_tr_b16 v[54:55], v29 offset:50848
    ds_read_b64_tr_b16 v[56:57], v29 offset:33984
    ds_read_b64_tr_b16 v[58:59], v29 offset:50880
    ds_read_b64_tr_b16 v[60:61], v29 offset:34016
    ds_read_b64_tr_b16 v[62:63], v29 offset:50912
    s_waitcnt lgkmcnt(8)
    s_mov_b32 s70, 0
LS6:
    ds_read_b32 v31, v24 offset:20
    ds_read_b128 v[12:15], v26
    s_waitcnt lgkmcnt(1)
    v_readfirstlane_b32 s69, v31
    s_add_u32 s70, s70, 1
    s_cmp_ge_u32 s69, 4
    s_cbranch_scc1 LSD6
    s_cmp_lt_u32 s70, 400000
    s_cbranch_scc1 LS6
LSD6:
    s_waitcnt lgkmcnt(0)
    v_max3_f32 v8, v12, v13, v14
    v_max_f32 v8, v8, v15
    v_sub_f32 v4, v4, v8
    v_sub_f32 v5, v5, v8
    v_sub_f32 v6, v6, v8
    v_sub_f32 v7, v7, v8
    v_mul_f32 v4, 0x3fb8aa3b, v4
    v_mul_f32 v5, 0x3fb8aa3b, v5
    v_mul_f32 v6, 0x3fb8aa3b, v6
    v_mul_f32 v7, 0x3fb8aa3b, v7
    v_exp_f32 v4, v4
    v_exp_f32 v5, v5
    v_exp_f32 v6, v6
    v_exp_f32 v7, v7
    s_nop 0
    v_cvt_pk_bf16_f32 v12, v4, v5
    v_cvt_pk_bf16_f32 v13, v6, v7
    ds_write_b64 v28, v[12:13]
    v_add_f32 v9, v4, v5
    v_add_f32 v10, v6, v7
    v_add_f32 v9, v9, v10
    s_nop 1
    v_add_f32_dpp v9, v9, v9 row_ror:8 row_mask:0xf bank_mask:0xf
    v_mov_b32 v10, v9
    s_nop 1
    v_permlane16_swap_b32 v9, v10
    s_nop 1
    v_add_f32 v9, v9, v10
    v_mov_b32 v10, v9
    s_nop 1
    v_permlane32_swap_b32 v9, v10
    s_nop 1
    v_add_f32 v9, v9, v10
    s_mov_b64 exec, 0xff
    ds_write_b32 v27, v9 offset:128
    s_mov_b64 exec, -1
    s_mov_b64 exec, 1
    ds_add_u32 v24, v23 offset:24
    s_mov_b64 exec, -1
    ds_read_b64_tr_b16 v[64:65], v30 offset:0
    ds_read_b64_tr_b16 v[66:67], v30 offset:16896
    ds_read_b64_tr_b16 v[68:69], v30 offset:32
    ds_read_b64_tr_b16 v[70:71], v30 offset:16928
    ds_read_b64_tr_b16 v[72:73], v30 offset:64
    ds_read_b64_tr_b16 v[74:75], v30 offset:16960
    ds_read_b64_tr_b16 v[76:77], v30 offset:96
    ds_read_b64_tr_b16 v[78:79], v30 offset:16992
    ds_read_b64_tr_b16 v[80:81], v30 offset:128
    ds_read_b64_tr_b16 v[82:83], v30 offset:17024
    s_waitcnt lgkmcnt(4)
    ds_read_b64_tr_b16 v[84:85], v30 offset:160
    ds_read_b64_tr_b16 v[86:87], v30 offset:17056
    ds_read_b64_tr_b16 v[88:89], v30 offset:192
    ds_read_b64_tr_b16 v[90:91], v30 offset:17088
    ds_read_b64_tr_b16 v[92:93], v30 offset:224
    ds_read_b64_tr_b16 v[94:95], v30 offset:17120
    s_waitcnt lgkmcnt(8)
    s_mov_b32 s70, 0
LS7:
    ds_read_b32 v31, v24 offset:24
    ds_read_b128 v[192:195], v20 offset:0
    ds_read_b128 v[196:199], v20 offset:64
    ds_read_b128 v[200:203], v20 offset:128
    ds_read_b128 v[204:207], v20 offset:192
    ds_read_b128 v[12:15], v26 offset:128
    s_waitcnt lgkmcnt(5)
    v_readfirstlane_b32 s69, v31
    s_add_u32 s70, s70, 1
    s_cmp_ge_u32 s69, 4
    s_cbranch_scc1 LSD7
    s_cmp_lt_u32 s70, 400000
    s_cbranch_scc1 LS7
LSD7:
    ds_read_b64_tr_b16 v[96:97], v30 offset:33792
    ds_read_b64_tr_b16 v[98:99], v30 offset:50688
    ds_read_b64_tr_b16 v[100:101], v30 offset:33824
    ds_read_b64_tr_b16 v[102:103], v30 offset:50720
    ds_read_b64_tr_b16 v[104:105], v30 offset:33856
    ds_read_b64_tr_b16 v[106:107], v30 offset:50752
    ds_read_b64_tr_b16 v[108:109], v30 offset:33888
    ds_read_b64_tr_b16 v[110:111], v30 offset:50784
    s_waitcnt lgkmcnt(12)
    v_mfma_f32_16x16x32_bf16 v[160:163], v[224:227], v[192:195], 0
    v_mfma_f32_16x16x32_bf16 v[164:167], v[228:231], v[192:195], 0
    v_mfma_f32_16x16x32_bf16 v[168:171], v[232:235], v[192:195], 0
    v_mfma_f32_16x16x32_bf16 v[172:175], v[236:239], v[192:195], 0
    v_mfma_f32_16x16x32_bf16 v[176:179], v[240:243], v[192:195], 0
    v_mfma_f32_16x16x32_bf16 v[180:183], v[244:247], v[192:195], 0
    v_mfma_f32_16x16x32_bf16 v[184:187], v[248:251], v[192:195], 0
    v_mfma_f32_16x16x32_bf16 v[188:191], v[252:255], v[192:195], 0
    s_waitcnt lgkmcnt(7)
    ds_read_b64_tr_b16 v[112:113], v30 offset:33920
    ds_read_b64_tr_b16 v[114:115], v30 offset:50816
    ds_read_b64_tr_b16 v[116:117], v30 offset:33952
    ds_read_b64_tr_b16 v[118:119], v30 offset:50848
    ds_read_b64_tr_b16 v[120:121], v30 offset:33984
    ds_read_b64_tr_b16 v[122:123], v30 offset:50880
    ds_read_b64_tr_b16 v[124:125], v30 offset:34016
    ds_read_b64_tr_b16 v[126:127], v30 offset:50912
    v_mfma_f32_16x16x32_bf16 v[160:163], v[32:35], v[196:199], v[160:163]
    v_mfma_f32_16x16x32_bf16 v[164:167], v[36:39], v[196:199], v[164:167]
    v_mfma_f32_16x16x32_bf16 v[168:171], v[40:43], v[196:199], v[168:171]
    v_mfma_f32_16x16x32_bf16 v[172:175], v[44:47], v[196:199], v[172:175]
    v_mfma_f32_16x16x32_bf16 v[176:179], v[48:51], v[196:199], v[176:179]
    v_mfma_f32_16x16x32_bf16 v[180:183], v[52:55], v[196:199], v[180:183]
    v_mfma_f32_16x16x32_bf16 v[184:187], v[56:59], v[196:199], v[184:187]
    v_mfma_f32_16x16x32_bf16 v[188:191], v[60:63], v[196:199], v[188:191]
    v_mfma_f32_16x16x32_bf16 v[160:163], v[64:67], v[200:203], v[160:163]
    v_mfma_f32_16x16x32_bf16 v[164:167], v[68:71], v[200:203], v[164:167]
    v_mfma_f32_16x16x32_bf16 v[168:171], v[72:75], v[200:203], v[168:171]
    v_mfma_f32_16x16x32_bf16 v[172:175], v[76:79], v[200:203], v[172:175]
    v_mfma_f32_16x16x32_bf16 v[176:179], v[80:83], v[200:203], v[176:179]
    v_mfma_f32_16x16x32_bf16 v[180:183], v[84:87], v[200:203], v[180:183]
    v_mfma_f32_16x16x32_bf16 v[184:187], v[88:91], v[200:203], v[184:187]
    v_mfma_f32_16x16x32_bf16 v[188:191], v[92:95], v[200:203], v[188:191]
    v_add_f32 v12, v12, v13
    v_add_f32 v14, v14, v15
    v_add_f32 v9, v12, v14
    v_and_b32 v12, 7, v2
    v_mul_u32_u24 v26, 1056, v12
    v_lshrrev_b32 v12, 3, v2
    v_lshl_add_u32 v26, v12, 7, v26
    v_lshl_add_u32 v26, v3, 5, v26
    s_lshl_b32 s64, s62, 8
    v_add_u32 v26, s64, v26
    v_mul_u32_u24 v27, 1056, v3
    v_lshl_add_u32 v27, v2, 4, v27
    v_add_u32 v27, s64, v27
    s_mov_b32 s65, 0x40000
    s_waitcnt lgkmcnt(12)
    v_mfma_f32_16x16x32_bf16 v[160:163], v[96:99], v[204:207], v[160:163]
    v_mfma_f32_16x16x32_bf16 v[164:167], v[100:103], v[204:207], v[164:167]
    s_waitcnt lgkmcnt(8)
    v_mfma_f32_16x16x32_bf16 v[168:171], v[104:107], v[204:207], v[168:171]
    v_mfma_f32_16x16x32_bf16 v[172:175], v[108:111], v[204:207], v[172:175]
    s_waitcnt lgkmcnt(4)
    v_mfma_f32_16x16x32_bf16 v[176:179], v[112:115], v[204:207], v[176:179]
    v_mfma_f32_16x16x32_bf16 v[180:183], v[116:119], v[204:207], v[180:183]
    s_waitcnt lgkmcnt(0)
    v_mfma_f32_16x16x32_bf16 v[184:187], v[120:123], v[204:207], v[184:187]
    v_mfma_f32_16x16x32_bf16 v[188:191], v[124:127], v[204:207], v[188:191]
    s_mov_b32 s70, 0
LS8:
    ds_read_b32 v31, v24 offset:12
    s_waitcnt lgkmcnt(0)
    v_readfirstlane_b32 s69, v31
    s_add_u32 s70, s70, 1
    s_cmp_ge_u32 s69, 1
    s_cbranch_scc1 LSD8
    s_cmp_lt_u32 s70, 400000
    s_cbranch_scc1 LS8
LSD8:
    buffer_store_dwordx2 v[8:9], v22, s[40:43], 0 offen sc1
    s_nop 3
    v_cvt_pk_bf16_f32 v32, v160, v161
    v_cvt_pk_bf16_f32 v33, v162, v163
    v_cvt_pk_bf16_f32 v34, v164, v165
    v_cvt_pk_bf16_f32 v35, v166, v167
    v_cvt_pk_bf16_f32 v36, v168, v169
    v_cvt_pk_bf16_f32 v37, v170, v171
    v_cvt_pk_bf16_f32 v38, v172, v173
    v_cvt_pk_bf16_f32 v39, v174, v175
    v_cvt_pk_bf16_f32 v40, v176, v177
    v_cvt_pk_bf16_f32 v41, v178, v179
    v_cvt_pk_bf16_f32 v42, v180, v181
    v_cvt_pk_bf16_f32 v43, v182, v183
    v_cvt_pk_bf16_f32 v44, v184, v185
    v_cvt_pk_bf16_f32 v45, v186, v187
    v_cvt_pk_bf16_f32 v46, v188, v189
    v_cvt_pk_bf16_f32 v47, v190, v191
    v_cndmask_b32 v12, v40, v32, vcc
    v_cndmask_b32 v13, v41, v33, vcc
    v_cndmask_b32 v14, v42, v34, vcc
    v_cndmask_b32 v15, v43, v35, vcc
    v_cndmask_b32 v16, v44, v36, vcc
    v_cndmask_b32 v17, v45, v37, vcc
    v_cndmask_b32 v18, v46, v38, vcc
    v_cndmask_b32 v19, v47, v39, vcc
    ds_write_b128 v26, v[12:15]
    ds_write_b128 v26, v[16:19] offset:16
    ds_read_b128 v[48:51], v27
    ds_read_b128 v[52:55], v27 offset:4224
    s_waitcnt lgkmcnt(1)
    buffer_store_dwordx4 v[48:51], v21, s[40:43], 0 offen sc1
    s_waitcnt lgkmcnt(0)
    buffer_store_dwordx4 v[52:55], v21, s[40:43], s65 offen sc1
    s_mov_b64 exec, 1
    ds_add_u32 v24, v23 offset:44
    s_mov_b64 exec, -1
    v_mov_b32 v117, v25
    s_cmp_eq_u32 s62, 0
    s_cselect_b32 s95, s95, 0
    s_cmp_eq_u32 s95, 0
    s_cbranch_scc1 JOIN
    v_lshlrev_b32 v27, 13, v3
    v_lshl_add_u32 v27, v2, 4, v27
    s_lshl_b32 s64, s61, 15
    s_lshl_b32 s65, s94, 8
    s_add_u32 s64, s64, s65
    buffer_load_dwordx4 v[160:163], v27, s[36:39], s64 offen offset:0 nt
    buffer_load_dwordx4 v[164:167], v27, s[36:39], s64 offen offset:1024 nt
    buffer_load_dwordx4 v[168:171], v27, s[36:39], s64 offen offset:2048 nt
    buffer_load_dwordx4 v[172:175], v27, s[36:39], s64 offen offset:3072 nt
    s_add_u32 s64, s64, 4096
    buffer_load_dwordx4 v[176:179], v27, s[36:39], s64 offen offset:0 nt
    buffer_load_dwordx4 v[180:183], v27, s[36:39], s64 offen offset:1024 nt
    buffer_load_dwordx4 v[184:187], v27, s[36:39], s64 offen offset:2048 nt
    buffer_load_dwordx4 v[188:191], v27, s[36:39], s64 offen offset:3072 nt
    v_and_b32 v118, 7, v2
    v_lshl_add_u32 v118, v118, 2, v3
    v_lshlrev_b32 v118, 1, v118
    s_lshl_b32 s64, s61, 6
    buffer_load_ushort v116, v118, s[48:51], s64 offen
    v_lshrrev_b32 v119, 3, v2
    v_lshlrev_b32 v119, 6, v119
    v_add_u32 v119, 159040, v119
    v_add_u32 v118, v118, v119
    v_lshl_add_u32 v119, v3, 4, v119
    v_lshrrev_b32 v12, 1, v3
    v_lshlrev_b32 v12, 5, v12
    v_lshrrev_b32 v13, 1, v2
    v_add_u32 v12, v12, v13
    s_lshl_b32 s64, s94, 3
    v_add_u32 v12, s64, v12
    v_and_b32 v13, 1, v2
    v_lshlrev_b32 v13, 5, v13
    v_and_b32 v14, 1, v3
    v_lshl_add_u32 v13, v14, 4, v13
    v_lshl_add_u32 v14, v12, 12, v13
    s_lshl_b32 s64, s61, 6
    s_add_u32 s64, s64, 3407872
    v_add_u32 v120, s64, v14
    s_lshl_b32 s64, s61, 10
    s_add_u32 s64, s64, 180224
    v_lshlrev_b32 v117, 4, v1
    v_add_u32 v117, s64, v117
    v_and_b32 v12, 7, v2
    v_lshrrev_b32 v13, 1, v12
    v_and_b32 v14, 1, v12
    s_mov_b32 s64, 0x0c0c0100
    s_mov_b32 s65, 0x01000c0c
    s_mov_b32 s66, 0x0c0c0302
    s_mov_b32 s67, 0x03020c0c
    v_cmp_eq_u32 vcc, 1, v14
    v_mov_b32 v15, s64
    v_mov_b32 v16, s65
    v_mov_b32 v17, s66
    v_mov_b32 v18, s67
    v_cndmask_b32 v15, v15, v16, vcc
    v_cndmask_b32 v17, v17, v18, vcc
    v_mov_b32 v16, 0x0c0c0c0c
    v_cmp_eq_u32 vcc, 0, v13
    v_cndmask_b32 v4, v16, v15, vcc
    v_cndmask_b32 v8, v16, v17, vcc
    v_cmp_eq_u32 vcc, 1, v13
    v_cndmask_b32 v5, v16, v15, vcc
    v_cndmask_b32 v9, v16, v17, vcc
    v_cmp_eq_u32 vcc, 2, v13
    v_cndmask_b32 v6, v16, v15, vcc
    v_cndmask_b32 v10, v16, v17, vcc
    v_cmp_eq_u32 vcc, 3, v13
    v_cndmask_b32 v7, v16, v15, vcc
    v_cndmask_b32 v11, v16, v17, vcc
    s_branch JOIN
KPATH:
    s_cmp_eq_u32 s62, 7
    s_cbranch_scc1 W7PATH
    s_cmp_lg_u32 s62, 4
    s_cbranch_scc1 K56
    v_lshlrev_b32 v26, 4, v1
    buffer_load_dwordx4 v[32:35], v26, s[8:11], 0 offen
    buffer_load_dwordx4 v[36:39], v26, s[8:11], 0 offen offset:1024
    v_mov_b32 v12, 0
    v_mov_b32 v13, 0
    v_mov_b32 v14, 0
    v_mov_b32 v15, 0
    ds_write_b128 v24, v[12:15]
    ds_write_b128 v24, v[12:15] offset:16
    ds_write_b128 v24, v[12:15] offset:32
    v_add_u32 v26, 152064, v26
    s_waitcnt lgkmcnt(0)
    s_barrier
    s_load_dword s96, s[90:91], 0
    v_and_b32 v12, 7, v2
    v_lshrrev_b32 v13, 1, v12
    v_and_b32 v14, 1, v12
    s_mov_b32 s64, 0x0c0c0100
    s_mov_b32 s65, 0x01000c0c
    s_mov_b32 s66, 0x0c0c0302
    s_mov_b32 s67, 0x03020c0c
    v_cmp_eq_u32 vcc, 1, v14
    v_mov_b32 v15, s64
    v_mov_b32 v16, s65
    v_mov_b32 v17, s66
    v_mov_b32 v18, s67
    v_cndmask_b32 v15, v15, v16, vcc
    v_cndmask_b32 v17, v17, v18, vcc
    v_mov_b32 v16, 0x0c0c0c0c
    v_cmp_eq_u32 vcc, 0, v13
    v_cndmask_b32 v4, v16, v15, vcc
    v_cndmask_b32 v8, v16, v17, vcc
    v_cmp_eq_u32 vcc, 1, v13
    v_cndmask_b32 v5, v16, v15, vcc
    v_cndmask_b32 v9, v16, v17, vcc
    v_cmp_eq_u32 vcc, 2, v13
    v_cndmask_b32 v6, v16, v15, vcc
    v_cndmask_b32 v10, v16, v17, vcc
    v_cmp_eq_u32 vcc, 3, v13
    v_cndmask_b32 v7, v16, v15, vcc
    v_cndmask_b32 v11, v16, v17, vcc
    s_waitcnt vmcnt(0)
    v_lshlrev_b32 v40, 16, v32
    v_and_b32 v41, 0xffff0000, v32
    v_lshlrev_b32 v42, 16, v33
    v_and_b32 v43, 0xffff0000, v33
    v_lshlrev_b32 v44, 16, v34
    v_and_b32 v45, 0xffff0000, v34
    v_lshlrev_b32 v46, 16, v35
    v_and_b32 v47, 0xffff0000, v35
    v_lshlrev_b32 v48, 16, v36
    v_and_b32 v49, 0xffff0000, v36
    v_lshlrev_b32 v50, 16, v37
    v_and_b32 v51, 0xffff0000, v37
    v_lshlrev_b32 v52, 16, v38
    v_and_b32 v53, 0xffff0000, v38
    v_lshlrev_b32 v54, 16, v39
    v_and_b32 v55, 0xffff0000, v39
    v_add_f32 v64, v40, v41
    v_add_f32 v68, v48, v49
    v_add_f32 v65, v42, v43
    v_add_f32 v69, v50, v51
    v_add_f32 v66, v44, v45
    v_add_f32 v70, v52, v53
    v_add_f32 v67, v46, v47
    v_add_f32 v71, v54, v55
    v_add_f32 v64, v64, v65
    v_add_f32 v66, v66, v67
    v_add_f32 v68, v68, v69
    v_add_f32 v70, v70, v71
    v_add_f32 v56, v64, v66
    v_add_f32 v57, v68, v70
    s_nop 1
    v_add_f32_dpp v56, v56, v56 row_ror:8 row_mask:0xf bank_mask:0xf
    v_add_f32_dpp v57, v57, v57 row_ror:8 row_mask:0xf bank_mask:0xf
    s_nop 1
    v_add_f32_dpp v56, v56, v56 row_ror:4 row_mask:0xf bank_mask:0xf
    v_add_f32_dpp v57, v57, v57 row_ror:4 row_mask:0xf bank_mask:0xf
    s_nop 1
    v_add_f32_dpp v56, v56, v56 row_ror:2 row_mask:0xf bank_mask:0xf
    v_add_f32_dpp v57, v57, v57 row_ror:2 row_mask:0xf bank_mask:0xf
    s_nop 1
    v_add_f32_dpp v56, v56, v56 row_ror:1 row_mask:0xf bank_mask:0xf
    v_add_f32_dpp v57, v57, v57 row_ror:1 row_mask:0xf bank_mask:0xf
    s_nop 1
    v_permlane32_swap_b32 v56, v57
    s_nop 1
    v_add_f32 v56, v56, v57
    v_mov_b32 v57, v56
    s_nop 1
    v_permlane16_swap_b32 v56, v57
    s_nop 1
    v_add_f32 v56, v56, v57
    v_mov_b32 v57, v56
    s_nop 1
    v_permlane32_swap_b32 v56, v57
    s_nop 1
    v_mul_f32 v56, 0x3b000000, v56
    v_mul_f32 v57, 0x3b000000, v57
    v_sub_f32 v64, v40, v56
    v_sub_f32 v72, v48, v57
    v_sub_f32 v65, v41, v56
    v_sub_f32 v73, v49, v57
    v_sub_f32 v66, v42, v56
    v_sub_f32 v74, v50, v57
    v_sub_f32 v67, v43, v56
    v_sub_f32 v75, v51, v57
    v_sub_f32 v68, v44, v56
    v_sub_f32 v76, v52, v57
    v_sub_f32 v69, v45, v56
    v_sub_f32 v77, v53, v57
    v_sub_f32 v70, v46, v56
    v_sub_f32 v78, v54, v57
    v_sub_f32 v71, v47, v56
    v_sub_f32 v79, v55, v57
    v_mul_f32 v58, v64, v64
    v_mul_f32 v60, v65, v65
    v_mul_f32 v59, v72, v72
    v_mul_f32 v61, v73, v73
    v_fmac_f32 v58, v66, v66
    v_fmac_f32 v60, v67, v67
    v_fmac_f32 v59, v74, v74
    v_fmac_f32 v61, v75, v75
    v_fmac_f32 v58, v68, v68
    v_fmac_f32 v60, v69, v69
    v_fmac_f32 v59, v76, v76
    v_fmac_f32 v61, v77, v77
    v_fmac_f32 v58, v70, v70
    v_fmac_f32 v60, v71, v71
    v_fmac_f32 v59, v78, v78
    v_fmac_f32 v61, v79, v79
    v_add_f32 v58, v58, v60
    v_add_f32 v59, v59, v61
    v_cvt_pk_bf16_f32 v60, v56, v57
    v_lshlrev_b32 v56, 16, v60
    v_and_b32 v57, 0xffff0000, v60
    s_nop 1
    v_add_f32_dpp v58, v58, v58 row_ror:8 row_mask:0xf bank_mask:0xf
    v_add_f32_dpp v59, v59, v59 row_ror:8 row_mask:0xf bank_mask:0xf
    s_nop 1
    v_add_f32_dpp v58, v58, v58 row_ror:4 row_mask:0xf bank_mask:0xf
    v_add_f32_dpp v59, v59, v59 row_ror:4 row_mask:0xf bank_mask:0xf
    s_nop 1
    v_add_f32_dpp v58, v58, v58 row_ror:2 row_mask:0xf bank_mask:0xf
    v_add_f32_dpp v59, v59, v59 row_ror:2 row_mask:0xf bank_mask:0xf
    s_nop 1
    v_add_f32_dpp v58, v58, v58 row_ror:1 row_mask:0xf bank_mask:0xf
    v_add_f32_dpp v59, v59, v59 row_ror:1 row_mask:0xf bank_mask:0xf
    s_nop 1
    v_permlane32_swap_b32 v58, v59
    s_nop 1
    v_add_f32 v58, v58, v59
    v_mov_b32 v59, v58
    s_nop 1
    v_permlane16_swap_b32 v58, v59
    s_nop 1
    v_add_f32 v58, v58, v59
    v_mov_b32 v59, v58
    s_nop 1
    v_permlane32_swap_b32 v58, v59
    s_nop 1
    v_sub_f32 v40, v40, v56
    v_sub_f32 v48, v48, v57
    v_sub_f32 v41, v41, v56
    v_sub_f32 v49, v49, v57
    v_sub_f32 v42, v42, v56
    v_sub_f32 v50, v50, v57
    v_sub_f32 v43, v43, v56
    v_sub_f32 v51, v51, v57
    v_sub_f32 v44, v44, v56
    v_sub_f32 v52, v52, v57
    v_sub_f32 v45, v45, v56
    v_sub_f32 v53, v53, v57
    v_sub_f32 v46, v46, v56
    v_sub_f32 v54, v54, v57
    v_sub_f32 v47, v47, v56
    v_sub_f32 v55, v55, v57
    v_mul_f32 v58, 0x3b000000, v58
    v_mul_f32 v59, 0x3b000000, v59
    v_cvt_pk_bf16_f32 v60, v58, v59
    v_lshlrev_b32 v58, 16, v60
    v_and_b32 v59, 0xffff0000, v60
    v_add_f32 v58, 0x3727c5ac, v58
    v_add_f32 v59, 0x3727c5ac, v59
    v_cvt_pk_bf16_f32 v60, v58, v59
    v_lshlrev_b32 v58, 16, v60
    v_and_b32 v59, 0xffff0000, v60
    v_sqrt_f32 v58, v58
    v_sqrt_f32 v59, v59
    v_cvt_pk_bf16_f32 v64, v40, v41
    v_lshlrev_b32 v40, 16, v64
    v_and_b32 v41, 0xffff0000, v64
    v_cvt_pk_bf16_f32 v66, v42, v43
    v_lshlrev_b32 v42, 16, v66
    v_and_b32 v43, 0xffff0000, v66
    v_cvt_pk_bf16_f32 v68, v44, v45
    v_lshlrev_b32 v44, 16, v68
    v_and_b32 v45, 0xffff0000, v68
    v_cvt_pk_bf16_f32 v70, v46, v47
    v_lshlrev_b32 v46, 16, v70
    v_and_b32 v47, 0xffff0000, v70
    v_cvt_pk_bf16_f32 v72, v48, v49
    v_lshlrev_b32 v48, 16, v72
    v_and_b32 v49, 0xffff0000, v72
    v_cvt_pk_bf16_f32 v74, v50, v51
    v_lshlrev_b32 v50, 16, v74
    v_and_b32 v51, 0xffff0000, v74
    v_cvt_pk_bf16_f32 v76, v52, v53
    v_lshlrev_b32 v52, 16, v76
    v_and_b32 v53, 0xffff0000, v76
    v_cvt_pk_bf16_f32 v78, v54, v55
    v_lshlrev_b32 v54, 16, v78
    v_and_b32 v55, 0xffff0000, v78
    v_cvt_pk_bf16_f32 v60, v58, v59
    v_lshlrev_b32 v58, 16, v60
    v_and_b32 v59, 0xffff0000, v60
    v_rcp_f32 v62, v58
    v_rcp_f32 v63, v59
    s_nop 0
    v_mul_f32 v64, v40, v62
    v_mul_f32 v65, v41, v62
    v_mul_f32 v66, v42, v62
    v_mul_f32 v67, v43, v62
    v_mul_f32 v68, v44, v62
    v_mul_f32 v69, v45, v62
    v_mul_f32 v70, v46, v62
    v_mul_f32 v71, v47, v62
    v_mul_f32 v72, v48, v63
    v_mul_f32 v73, v49, v63
    v_mul_f32 v74, v50, v63
    v_mul_f32 v75, v51, v63
    v_mul_f32 v76, v52, v63
    v_mul_f32 v77, v53, v63
    v_mul_f32 v78, v54, v63
    v_mul_f32 v79, v55, v63
    v_fma_f32 v40, -v64, v58, v40
    v_fma_f32 v41, -v65, v58, v41
    v_fma_f32 v42, -v66, v58, v42
    v_fma_f32 v43, -v67, v58, v43
    v_fma_f32 v44, -v68, v58, v44
    v_fma_f32 v45, -v69, v58, v45
    v_fma_f32 v46, -v70, v58, v46
    v_fma_f32 v47, -v71, v58, v47
    v_fma_f32 v48, -v72, v59, v48
    v_fma_f32 v49, -v73, v59, v49
    v_fma_f32 v50, -v74, v59, v50
    v_fma_f32 v51, -v75, v59, v51
    v_fma_f32 v52, -v76, v59, v52
    v_fma_f32 v53, -v77, v59, v53
    v_fma_f32 v54, -v78, v59, v54
    v_fma_f32 v55, -v79, v59, v55
    v_fma_f32 v40, v40, v62, v64
    v_fma_f32 v41, v41, v62, v65
    v_fma_f32 v42, v42, v62, v66
    v_fma_f32 v43, v43, v62, v67
    v_fma_f32 v44, v44, v62, v68
    v_fma_f32 v45, v45, v62, v69
    v_fma_f32 v46, v46, v62, v70
    v_fma_f32 v47, v47, v62, v71
    v_fma_f32 v48, v48, v63, v72
    v_fma_f32 v49, v49, v63, v73
    v_fma_f32 v50, v50, v63, v74
    v_fma_f32 v51, v51, v63, v75
    v_fma_f32 v52, v52, v63, v76
    v_fma_f32 v53, v53, v63, v77
    v_fma_f32 v54, v54, v63, v78
    v_fma_f32 v55, v55, v63, v79
    v_cvt_pk_bf16_f32 v32, v40, v41
    v_cvt_pk_bf16_f32 v33, v42, v43
    v_cvt_pk_bf16_f32 v34, v44, v45
    v_cvt_pk_bf16_f32 v35, v46, v47
    v_cvt_pk_bf16_f32 v36, v48, v49
    v_cvt_pk_bf16_f32 v37, v50, v51
    v_cvt_pk_bf16_f32 v38, v52, v53
    v_cvt_pk_bf16_f32 v39, v54, v55
    ds_write_b128 v26, v[32:35]
    ds_write_b128 v26, v[36:39] offset:1024
    s_mov_b64 exec, 1
    ds_add_u32 v24, v23 offset:4
    s_mov_b64 exec, -1
    s_branch KBA
K56:
    s_load_dword s96, s[90:91], 0
    s_barrier
    v_and_b32 v12, 7, v2
    v_lshrrev_b32 v13, 1, v12
    v_and_b32 v14, 1, v12
    s_mov_b32 s64, 0x0c0c0100
    s_mov_b32 s65, 0x01000c0c
    s_mov_b32 s66, 0x0c0c0302
    s_mov_b32 s67, 0x03020c0c
    v_cmp_eq_u32 vcc, 1, v14
    v_mov_b32 v15, s64
    v_mov_b32 v16, s65
    v_mov_b32 v17, s66
    v_mov_b32 v18, s67
    v_cndmask_b32 v15, v15, v16, vcc
    v_cndmask_b32 v17, v17, v18, vcc
    v_mov_b32 v16, 0x0c0c0c0c
    v_cmp_eq_u32 vcc, 0, v13
    v_cndmask_b32 v4, v16, v15, vcc
    v_cndmask_b32 v8, v16, v17, vcc
    v_cmp_eq_u32 vcc, 1, v13
    v_cndmask_b32 v5, v16, v15, vcc
    v_cndmask_b32 v9, v16, v17, vcc
    v_cmp_eq_u32 vcc, 2, v13
    v_cndmask_b32 v6, v16, v15, vcc
    v_cndmask_b32 v10, v16, v17, vcc
    v_cmp_eq_u32 vcc, 3, v13
    v_cndmask_b32 v7, v16, v15, vcc
    v_cndmask_b32 v11, v16, v17, vcc
    s_waitcnt lgkmcnt(0)
    s_mul_i32 s63, s96, 1664525
    s_add_u32 s63, s63, 1013904223
    v_mov_b32 v12, s63
    ds_write_b32 v24, v12 offset:40
    s_mov_b64 exec, 1
    ds_add_u32 v24, v23 offset:0
    s_mov_b64 exec, -1
KBA:
    v_lshlrev_b32 v26, 4, v1
    s_sub_u32 s66, s62, 4
    s_lshl_b32 s67, s60, 17
    s_lshl_b32 s68, s56, 5
    s_add_u32 s68, s68, s66
    s_mov_b32 s70, 0
LS9:
    ds_read_b32 v31, v24 offset:28
    s_waitcnt lgkmcnt(0)
    v_readfirstlane_b32 s69, v31
    s_add_u32 s70, s70, 1
    s_cmp_ge_u32 s69, 4
    s_cbranch_scc1 LSD9
    s_cmp_lt_u32 s70, 400000
    s_cbranch_scc1 LS9
LSD9:
KCI:
    s_and_b32 s68, s68, 127
    s_mul_i32 m0, s68, 1056
    s_lshl_b32 s64, s68, 10
    s_add_u32 s64, s64, s67
    buffer_load_dwordx4 v26, s[12:15], s64 offen lds
    s_add_u32 s68, s68, 3
    s_and_b32 s68, s68, 127
    s_mul_i32 m0, s68, 1056
    s_lshl_b32 s64, s68, 10
    s_add_u32 s64, s64, s67
    buffer_load_dwordx4 v26, s[12:15], s64 offen lds
    s_add_u32 s68, s68, 3
    s_and_b32 s68, s68, 127
    s_mul_i32 m0, s68, 1056
    s_lshl_b32 s64, s68, 10
    s_add_u32 s64, s64, s67
    buffer_load_dwordx4 v26, s[12:15], s64 offen lds
    s_add_u32 s68, s68, 3
    s_and_b32 s68, s68, 127
    s_mul_i32 m0, s68, 1056
    s_lshl_b32 s64, s68, 10
    s_add_u32 s64, s64, s67
    buffer_load_dwordx4 v26, s[12:15], s64 offen lds
    s_add_u32 s68, s68, 3
    s_and_b32 s68, s68, 127
    s_mul_i32 m0, s68, 1056
    s_lshl_b32 s64, s68, 10
    s_add_u32 s64, s64, s67
    buffer_load_dwordx4 v26, s[12:15], s64 offen lds
    s_add_u32 s68, s68, 3
    s_and_b32 s68, s68, 127
    s_mul_i32 m0, s68, 1056
    s_lshl_b32 s64, s68, 10
    s_add_u32 s64, s64, s67
    buffer_load_dwordx4 v26, s[12:15], s64 offen lds
    s_add_u32 s68, s68, 3
    s_and_b32 s68, s68, 127
    s_mul_i32 m0, s68, 1056
    s_lshl_b32 s64, s68, 10
    s_add_u32 s64, s64, s67
    buffer_load_dwordx4 v26, s[12:15], s64 offen lds
    s_add_u32 s68, s68, 3
    s_and_b32 s68, s68, 127
    s_mul_i32 m0, s68, 1056
    s_lshl_b32 s64, s68, 10
    s_add_u32 s64, s64, s67
    buffer_load_dwordx4 v26, s[12:15], s64 offen lds
    s_add_u32 s68, s68, 3
    s_and_b32 s68, s68, 127
    s_mul_i32 m0, s68, 1056
    s_lshl_b32 s64, s68, 10
    s_add_u32 s64, s64, s67
    buffer_load_dwordx4 v26, s[12:15], s64 offen lds
    s_add_u32 s68, s68, 3
    s_and_b32 s68, s68, 127
    s_mul_i32 m0, s68, 1056
    s_lshl_b32 s64, s68, 10
    s_add_u32 s64, s64, s67
    buffer_load_dwordx4 v26, s[12:15], s64 offen lds
    s_add_u32 s68, s68, 3
    s_and_b32 s68, s68, 127
    s_mul_i32 m0, s68, 1056
    s_lshl_b32 s64, s68, 10
    s_add_u32 s64, s64, s67
    buffer_load_dwordx4 v26, s[12:15], s64 offen lds
    s_add_u32 s68, s68, 3
    s_and_b32 s68, s68, 127
    s_mul_i32 m0, s68, 1056
    s_lshl_b32 s64, s68, 10
    s_add_u32 s64, s64, s67
    buffer_load_dwordx4 v26, s[12:15], s64 offen lds
    s_add_u32 s68, s68, 3
    s_and_b32 s68, s68, 127
    s_mul_i32 m0, s68, 1056
    s_lshl_b32 s64, s68, 10
    s_add_u32 s64, s64, s67
    buffer_load_dwordx4 v26, s[12:15], s64 offen lds
    s_add_u32 s68, s68, 3
    s_and_b32 s68, s68, 127
    s_mul_i32 m0, s68, 1056
    s_lshl_b32 s64, s68, 10
    s_add_u32 s64, s64, s67
    buffer_load_dwordx4 v26, s[12:15], s64 offen lds
    s_add_u32 s68, s68, 3
    s_and_b32 s68, s68, 127
    s_mul_i32 m0, s68, 1056
    s_lshl_b32 s64, s68, 10
    s_add_u32 s64, s64, s67
    buffer_load_dwordx4 v26, s[12:15], s64 offen lds
    s_add_u32 s68, s68, 3
    s_and_b32 s68, s68, 127
    s_mul_i32 m0, s68, 1056
    s_lshl_b32 s64, s68, 10
    s_add_u32 s64, s64, s67
    buffer_load_dwordx4 v26, s[12:15], s64 offen lds
    s_add_u32 s68, s68, 3
    s_and_b32 s68, s68, 127
    s_mul_i32 m0, s68, 1056
    s_lshl_b32 s64, s68, 10
    s_add_u32 s64, s64, s67
    buffer_load_dwordx4 v26, s[12:15], s64 offen lds
    s_add_u32 s68, s68, 3
    s_and_b32 s68, s68, 127
    s_mul_i32 m0, s68, 1056
    s_lshl_b32 s64, s68, 10
    s_add_u32 s64, s64, s67
    buffer_load_dwordx4 v26, s[12:15], s64 offen lds
    s_add_u32 s68, s68, 3
    s_and_b32 s68, s68, 127
    s_mul_i32 m0, s68, 1056
    s_lshl_b32 s64, s68, 10
    s_add_u32 s64, s64, s67
    buffer_load_dwordx4 v26, s[12:15], s64 offen lds
    s_add_u32 s68, s68, 3
    s_and_b32 s68, s68, 127
    s_mul_i32 m0, s68, 1056
    s_lshl_b32 s64, s68, 10
    s_add_u32 s64, s64, s67
    buffer_load_dwordx4 v26, s[12:15], s64 offen lds
    s_add_u32 s68, s68, 3
    s_and_b32 s68, s68, 127
    s_mul_i32 m0, s68, 1056
    s_lshl_b32 s64, s68, 10
    s_add_u32 s64, s64, s67
    buffer_load_dwordx4 v26, s[12:15], s64 offen lds
    s_add_u32 s68, s68, 3
    s_and_b32 s68, s68, 127
    s_mul_i32 m0, s68, 1056
    s_lshl_b32 s64, s68, 10
    s_add_u32 s64, s64, s67
    buffer_load_dwordx4 v26, s[12:15], s64 offen lds
    s_add_u32 s68, s68, 3
    s_and_b32 s68, s68, 127
    s_mul_i32 m0, s68, 1056
    s_lshl_b32 s64, s68, 10
    s_add_u32 s64, s64, s67
    buffer_load_dwordx4 v26, s[12:15], s64 offen lds
    s_add_u32 s68, s68, 3
    s_and_b32 s68, s68, 127
    s_mul_i32 m0, s68, 1056
    s_lshl_b32 s64, s68, 10
    s_add_u32 s64, s64, s67
    buffer_load_dwordx4 v26, s[12:15], s64 offen lds
    s_add_u32 s68, s68, 3
    s_and_b32 s68, s68, 127
    s_mul_i32 m0, s68, 1056
    s_lshl_b32 s64, s68, 10
    s_add_u32 s64, s64, s67
    buffer_load_dwordx4 v26, s[12:15], s64 offen lds
    s_add_u32 s68, s68, 3
    s_and_b32 s68, s68, 127
    s_mul_i32 m0, s68, 1056
    s_lshl_b32 s64, s68, 10
    s_add_u32 s64, s64, s67
    buffer_load_dwordx4 v26, s[12:15], s64 offen lds
    s_add_u32 s68, s68, 3
    s_and_b32 s68, s68, 127
    s_mul_i32 m0, s68, 1056
    s_lshl_b32 s64, s68, 10
    s_add_u32 s64, s64, s67
    buffer_load_dwordx4 v26, s[12:15], s64 offen lds
    s_add_u32 s68, s68, 3
    s_and_b32 s68, s68, 127
    s_mul_i32 m0, s68, 1056
    s_lshl_b32 s64, s68, 10
    s_add_u32 s64, s64, s67
    buffer_load_dwordx4 v26, s[12:15], s64 offen lds
    s_add_u32 s68, s68, 3
    s_and_b32 s68, s68, 127
    s_mul_i32 m0, s68, 1056
    s_lshl_b32 s64, s68, 10
    s_add_u32 s64, s64, s67
    buffer_load_dwordx4 v26, s[12:15], s64 offen lds
    s_add_u32 s68, s68, 3
    s_and_b32 s68, s68, 127
    s_mul_i32 m0, s68, 1056
    s_lshl_b32 s64, s68, 10
    s_add_u32 s64, s64, s67
    buffer_load_dwordx4 v26, s[12:15], s64 offen lds
    s_add_u32 s68, s68, 3
    s_and_b32 s68, s68, 127
    s_mul_i32 m0, s68, 1056
    s_lshl_b32 s64, s68, 10
    s_add_u32 s64, s64, s67
    buffer_load_dwordx4 v26, s[12:15], s64 offen lds
    s_add_u32 s68, s68, 3
    s_and_b32 s68, s68, 127
    s_mul_i32 m0, s68, 1056
    s_lshl_b32 s64, s68, 10
    s_add_u32 s64, s64, s67
    buffer_load_dwordx4 v26, s[12:15], s64 offen lds
    s_add_u32 s68, s68, 3
    s_and_b32 s68, s68, 127
    s_mul_i32 m0, s68, 1056
    s_lshl_b32 s64, s68, 10
    s_add_u32 s64, s64, s67
    buffer_load_dwordx4 v26, s[12:15], s64 offen lds
    s_add_u32 s68, s68, 3
    s_and_b32 s68, s68, 127
    s_mul_i32 m0, s68, 1056
    s_lshl_b32 s64, s68, 10
    s_add_u32 s64, s64, s67
    buffer_load_dwordx4 v26, s[12:15], s64 offen lds
    s_add_u32 s68, s68, 3
    s_and_b32 s68, s68, 127
    s_mul_i32 m0, s68, 1056
    s_lshl_b32 s64, s68, 10
    s_add_u32 s64, s64, s67
    buffer_load_dwordx4 v26, s[12:15], s64 offen lds
    s_add_u32 s68, s68, 3
    s_and_b32 s68, s68, 127
    s_mul_i32 m0, s68, 1056
    s_lshl_b32 s64, s68, 10
    s_add_u32 s64, s64, s67
    buffer_load_dwordx4 v26, s[12:15], s64 offen lds
    s_add_u32 s68, s68, 3
    s_and_b32 s68, s68, 127
    s_mul_i32 m0, s68, 1056
    s_lshl_b32 s64, s68, 10
    s_add_u32 s64, s64, s67
    buffer_load_dwordx4 v26, s[12:15], s64 offen lds
    s_add_u32 s68, s68, 3
    s_and_b32 s68, s68, 127
    s_mul_i32 m0, s68, 1056
    s_lshl_b32 s64, s68, 10
    s_add_u32 s64, s64, s67
    buffer_load_dwordx4 v26, s[12:15], s64 offen lds
    s_add_u32 s68, s68, 3
    s_and_b32 s68, s68, 127
    s_mul_i32 m0, s68, 1056
    s_lshl_b32 s64, s68, 10
    s_add_u32 s64, s64, s67
    buffer_load_dwordx4 v26, s[12:15], s64 offen lds
    s_add_u32 s68, s68, 3
    s_and_b32 s68, s68, 127
    s_mul_i32 m0, s68, 1056
    s_lshl_b32 s64, s68, 10
    s_add_u32 s64, s64, s67
    buffer_load_dwordx4 v26, s[12:15], s64 offen lds
    s_add_u32 s68, s68, 3
    s_and_b32 s68, s68, 127
    s_mul_i32 m0, s68, 1056
    s_lshl_b32 s64, s68, 10
    s_add_u32 s64, s64, s67
    buffer_load_dwordx4 v26, s[12:15], s64 offen lds
    s_add_u32 s68, s68, 3
    s_and_b32 s68, s68, 127
    s_mul_i32 m0, s68, 1056
    s_lshl_b32 s64, s68, 10
    s_add_u32 s64, s64, s67
    buffer_load_dwordx4 v26, s[12:15], s64 offen lds
    s_add_u32 s68, s68, 3
    s_cmp_eq_u32 s66, 2
    s_cbranch_scc1 KD1
    s_and_b32 s68, s68, 127
    s_mul_i32 m0, s68, 1056
    s_lshl_b32 s64, s68, 10
    s_add_u32 s64, s64, s67
    buffer_load_dwordx4 v26, s[12:15], s64 offen lds
KD1:
    s_mov_b64 exec, 1
    ds_add_u32 v24, v23 offset:32
    s_mov_b64 exec, -1
    s_mul_i32 s63, s96, 1664525
    s_add_u32 s63, s63, 1013904223
    s_waitcnt vmcnt(0)
    s_mov_b64 exec, 1
    ds_add_u32 v24, v23 offset:8
    s_mov_b64 exec, -1
    s_mov_b32 s70, 0
LS10:
    ds_read_b32 v31, v24 offset:16
    s_waitcnt lgkmcnt(0)
    v_readfirstlane_b32 s69, v31
    s_add_u32 s70, s70, 1
    s_cmp_ge_u32 s69, 4
    s_cbranch_scc1 LSD10
    s_cmp_lt_u32 s70, 400000
    s_cbranch_scc1 LS10
LSD10:
    s_mov_b32 s97, s69
    s_cmp_lg_u32 s62, 6
    s_cbranch_scc1 KF0
    s_movk_i32 s64, 4096
    buffer_load_dwordx4 v[16:19], v26, s[40:43], s64 offen sc1
KF0:
    v_lshrrev_b32 v12, 3, v1
    v_and_b32 v13, 2, v12
    v_and_b32 v14, 7, v1
    v_xor_b32 v13, v13, v14
    s_and_b32 s64, s66, 1
    s_lshl_b32 s64, s64, 2
    v_xor_b32 v13, s64, v13
    v_lshlrev_b32 v12, 13, v12
    v_lshl_add_u32 v27, v13, 4, v12
    s_lshl_b32 s64, s58, 20
    s_lshl_b32 s65, s66, 18
    s_add_u32 s64, s64, s65
    s_add_u32 s64, s64, s7
    buffer_load_dwordx4 v[224:227], v27, s[24:27], s64 offen nt
    s_add_u32 s64, s64, 65536
    buffer_load_dwordx4 v[228:231], v27, s[24:27], s64 offen nt
    s_add_u32 s64, s64, 65536
    buffer_load_dwordx4 v[232:235], v27, s[24:27], s64 offen nt
    s_add_u32 s64, s64, 65536
    buffer_load_dwordx4 v[236:239], v27, s[24:27], s64 offen nt
    v_lshlrev_b32 v26, 14, v3
    v_lshl_add_u32 v26, v2, 4, v26
    v_mov_b32 v150, v26
    s_lshl_b32 s67, s7, 9
    s_lshl_b32 s65, s66, 8
    s_add_u32 s67, s67, s65
    s_branch KWO
W7PATH:
    s_load_dword s96, s[90:91], 0
    v_mov_b32 v16, 0
    v_mov_b32 v30, 0
    v_mov_b32 v26, 0
    v_mov_b32 v12, -1
    v_mov_b32 v13, -1
    v_mov_b32 v14, -1
    v_mov_b32 v15, -1
    v_lshlrev_b32 v27, 14, v3
    v_lshl_add_u32 v27, v2, 4, v27
    s_lshl_b32 s64, s56, 19
    s_lshl_b32 s65, s60, 8
    s_add_u32 s64, s64, s65
    s_add_u32 s64, s64, 262144
    s_barrier
W7C:
    buffer_store_dwordx4 v[12:15], v27, s[40:43], s64 offen sc1
    s_add_u32 s64, s64, 65536
    buffer_store_dwordx4 v[12:15], v27, s[40:43], s64 offen sc1
    s_add_u32 s64, s64, 65536
    buffer_store_dwordx4 v[12:15], v27, s[40:43], s64 offen sc1
    s_add_u32 s64, s64, 65536
    buffer_store_dwordx4 v[12:15], v27, s[40:43], s64 offen sc1
    s_add_u32 s64, s64, 65536
    buffer_store_dwordx4 v[12:15], v27, s[40:43], s64 offen sc1
    s_add_u32 s64, s64, 65536
    buffer_store_dwordx4 v[12:15], v27, s[40:43], s64 offen sc1
    s_add_u32 s64, s64, 65536
    buffer_store_dwordx4 v[12:15], v27, s[40:43], s64 offen sc1
    s_add_u32 s64, s64, 65536
    buffer_store_dwordx4 v[12:15], v27, s[40:43], s64 offen sc1
    v_lshrrev_b32 v28, 2, v1
    v_and_b32 v29, 3, v1
    v_lshlrev_b32 v29, 4, v29
    v_lshl_add_u32 v27, v28, 14, v29
    s_lshl_b32 s64, s2, 6
    s_add_u32 s64, s64, 2359296
    buffer_store_dwordx4 v[12:15], v27, s[40:43], s64 offen sc1
    s_add_u32 s64, s64, 262144
    buffer_store_dwordx4 v[12:15], v27, s[40:43], s64 offen sc1
    s_add_u32 s64, s64, 262144
    buffer_store_dwordx4 v[12:15], v27, s[40:43], s64 offen sc1
    s_add_u32 s64, s64, 262144
    buffer_store_dwordx4 v[12:15], v27, s[40:43], s64 offen sc1
    v_lshlrev_b32 v27, 9, v1
    v_cmp_gt_u32 vcc, 8, v1
    v_cndmask_b32 v27, v25, v27, vcc
    s_lshl_b32 s64, s56, 12
    s_lshl_b32 s65, s60, 3
    s_add_u32 s64, s64, s65
    s_add_u32 s64, s64, 163840
    buffer_store_dwordx2 v[12:13], v27, s[40:43], s64 offen sc1
    s_cmp_eq_u32 s95, 0
    s_cbranch_scc1 W7NF
    v_lshlrev_b32 v27, 4, v1
    v_cmp_gt_u32 vcc, 16, v1
    v_cndmask_b32 v27, v25, v27, vcc
    s_lshl_b32 s64, s61, 10
    s_lshl_b32 s65, s94, 8
    s_add_u32 s64, s64, s65
    s_add_u32 s71, s64, 180224
    buffer_store_dwordx4 v[12:15], v27, s[40:43], s71 offen sc1
    v_lshrrev_b32 v27, 5, v1
    v_lshlrev_b32 v27, 17, v27
    v_and_b32 v28, 7, v28
    v_lshl_add_u32 v27, v28, 12, v27
    v_add_u32 v27, v27, v29
    s_lshl_b32 s64, s94, 15
    s_lshl_b32 s65, s61, 6
    s_add_u32 s64, s64, s65
    s_add_u32 s64, s64, 3407872
    buffer_store_dwordx4 v[12:15], v27, s[40:43], s64 offen sc1
    v_lshrrev_b32 v27, 2, v2
    v_lshl_add_u32 v27, v3, 5, v27
    s_lshl_b32 s64, s94, 7
    v_add_u32 v27, s64, v27
    s_movk_i32 s64, 2752
    v_mul_lo_u32 v27, v27, s64
    v_and_b32 v28, 3, v2
    v_lshl_add_u32 v27, v28, 4, v27
    v_mov_b32 v30, v27
    v_and_b32 v12, 7, v2
    v_lshrrev_b32 v13, 1, v12
    v_and_b32 v14, 1, v12
    s_mov_b32 s64, 0x0c0c0100
    s_mov_b32 s65, 0x01000c0c
    s_mov_b32 s66, 0x0c0c0302
    s_mov_b32 s67, 0x03020c0c
    v_cmp_eq_u32 vcc, 1, v14
    v_mov_b32 v15, s64
    v_mov_b32 v16, s65
    v_mov_b32 v17, s66
    v_mov_b32 v18, s67
    v_cndmask_b32 v15, v15, v16, vcc
    v_cndmask_b32 v17, v17, v18, vcc
    v_mov_b32 v16, 0x0c0c0c0c
    v_cmp_eq_u32 vcc, 0, v13
    v_cndmask_b32 v4, v16, v15, vcc
    v_cndmask_b32 v8, v16, v17, vcc
    v_cmp_eq_u32 vcc, 1, v13
    v_cndmask_b32 v5, v16, v15, vcc
    v_cndmask_b32 v9, v16, v17, vcc
    v_cmp_eq_u32 vcc, 2, v13
    v_cndmask_b32 v6, v16, v15, vcc
    v_cndmask_b32 v10, v16, v17, vcc
    v_cmp_eq_u32 vcc, 3, v13
    v_cndmask_b32 v7, v16, v15, vcc
    v_cndmask_b32 v11, v16, v17, vcc
    v_lshrrev_b32 v27, 3, v2
    v_lshlrev_b32 v27, 10, v27
    v_lshl_add_u32 v27, v3, 6, v27
    s_lshl_b32 s64, s94, 8
    s_add_u32 s64, s64, 152064
    v_add_u32 v27, s64, v27
    v_mov_b32 v26, v27
    s_branch W7A
W7NF:
    v_and_b32 v12, 7, v2
    v_lshrrev_b32 v13, 1, v12
    v_and_b32 v14, 1, v12
    s_mov_b32 s64, 0x0c0c0100
    s_mov_b32 s65, 0x01000c0c
    s_mov_b32 s66, 0x0c0c0302
    s_mov_b32 s67, 0x03020c0c
    v_cmp_eq_u32 vcc, 1, v14
    v_mov_b32 v15, s64
    v_mov_b32 v16, s65
    v_mov_b32 v17, s66
    v_mov_b32 v18, s67
    v_cndmask_b32 v15, v15, v16, vcc
    v_cndmask_b32 v17, v17, v18, vcc
    v_mov_b32 v16, 0x0c0c0c0c
    v_cmp_eq_u32 vcc, 0, v13
    v_cndmask_b32 v4, v16, v15, vcc
    v_cndmask_b32 v8, v16, v17, vcc
    v_cmp_eq_u32 vcc, 1, v13
    v_cndmask_b32 v5, v16, v15, vcc
    v_cndmask_b32 v9, v16, v17, vcc
    v_cmp_eq_u32 vcc, 2, v13
    v_cndmask_b32 v6, v16, v15, vcc
    v_cndmask_b32 v10, v16, v17, vcc
    v_cmp_eq_u32 vcc, 3, v13
    v_cndmask_b32 v7, v16, v15, vcc
    v_cndmask_b32 v11, v16, v17, vcc
W7A:
    s_waitcnt vmcnt(0) lgkmcnt(0)
    s_mov_b64 exec, 1
    ds_add_u32 v24, v23 offset:12
    s_mov_b64 exec, -1
    s_mul_i32 s64, s96, 1664525
    s_add_u32 s63, s64, 1013904223
    v_mov_b32 v13, s63
    v_cmp_eq_u32 vcc, 0, v1
    v_mov_b32 v13, s63
    v_mov_b32 v12, 0
    v_cmp_eq_u32 vcc, 0, v1
    v_cndmask_b32 v12, v25, v12, vcc
    s_lshl_b32 s64, s2, 2
    s_add_u32 s64, s64, 4096
    buffer_store_dword v13, v12, s[40:43], s64 offen sc1
    s_mov_b32 s66, 3
    s_mov_b32 s70, 0
LS11:
    ds_read_b32 v31, v24 offset:16
    ds_read_b128 v[240:243], v26 offset:0
    ds_read_b128 v[244:247], v26 offset:16
    ds_read_b128 v[248:251], v26 offset:32
    ds_read_b128 v[252:255], v26 offset:48
    s_waitcnt lgkmcnt(4)
    v_readfirstlane_b32 s69, v31
    s_add_u32 s70, s70, 1
    s_cmp_ge_u32 s69, 4
    s_cbranch_scc1 LSD11
    s_cmp_lt_u32 s70, 400000
    s_cbranch_scc1 LS11
LSD11:
    s_mov_b32 s97, s69
    s_cmp_eq_u32 s95, 0
    s_cbranch_scc1 W7G
    s_lshl_b32 s64, s61, 6
    buffer_load_dwordx4 v[32:35], v30, s[32:35], s64 offen nt
    s_add_u32 s64, s64, 11008
    buffer_load_dwordx4 v[36:39], v30, s[32:35], s64 offen nt
    s_add_u32 s64, s64, 11008
    buffer_load_dwordx4 v[40:43], v30, s[32:35], s64 offen nt
    s_add_u32 s64, s64, 11008
    buffer_load_dwordx4 v[44:47], v30, s[32:35], s64 offen nt
    s_add_u32 s64, s64, 11008
    buffer_load_dwordx4 v[48:51], v30, s[32:35], s64 offen nt
    s_add_u32 s64, s64, 11008
    buffer_load_dwordx4 v[52:55], v30, s[32:35], s64 offen nt
    s_add_u32 s64, s64, 11008
    buffer_load_dwordx4 v[56:59], v30, s[32:35], s64 offen nt
    s_add_u32 s64, s64, 11008
    buffer_load_dwordx4 v[60:63], v30, s[32:35], s64 offen nt
W7G:
    v_lshrrev_b32 v12, 3, v1
    v_and_b32 v13, 2, v12
    v_and_b32 v14, 7, v1
    v_xor_b32 v13, v13, v14
    s_and_b32 s64, s66, 1
    s_lshl_b32 s64, s64, 2
    v_xor_b32 v13, s64, v13
    v_lshlrev_b32 v12, 13, v12
    v_lshl_add_u32 v27, v13, 4, v12
    s_lshl_b32 s64, s58, 20
    s_lshl_b32 s65, s66, 18
    s_add_u32 s64, s64, s65
    s_add_u32 s64, s64, s7
    buffer_load_dwordx4 v[224:227], v27, s[24:27], s64 offen nt
    s_add_u32 s64, s64, 65536
    buffer_load_dwordx4 v[228:231], v27, s[24:27], s64 offen nt
    s_add_u32 s64, s64, 65536
    buffer_load_dwordx4 v[232:235], v27, s[24:27], s64 offen nt
    s_add_u32 s64, s64, 65536
    buffer_load_dwordx4 v[236:239], v27, s[24:27], s64 offen nt
    v_lshlrev_b32 v26, 14, v3
    v_lshl_add_u32 v26, v2, 4, v26
    v_mov_b32 v150, v26
    s_lshl_b32 s67, s7, 9
    s_lshl_b32 s65, s66, 8
    s_add_u32 s67, s67, s65
    s_cmp_eq_u32 s95, 0
    s_cbranch_scc1 KWO
    s_waitcnt lgkmcnt(0)
    v_perm_b32 v96, v240, v240, v4
    v_perm_b32 v97, v240, v240, v5
    v_perm_b32 v98, v240, v240, v6
    v_perm_b32 v99, v240, v240, v7
    v_perm_b32 v100, v240, v240, v8
    v_perm_b32 v101, v240, v240, v9
    v_perm_b32 v102, v240, v240, v10
    v_perm_b32 v103, v240, v240, v11
    v_perm_b32 v104, v241, v241, v4
    v_perm_b32 v105, v241, v241, v5
    v_perm_b32 v106, v241, v241, v6
    v_perm_b32 v107, v241, v241, v7
    v_perm_b32 v108, v241, v241, v8
    v_perm_b32 v109, v241, v241, v9
    v_perm_b32 v110, v241, v241, v10
    v_perm_b32 v111, v241, v241, v11
    s_waitcnt vmcnt(11)
    v_mfma_f32_16x16x32_bf16 v[128:131], v[96:99], v[32:35], 0
    v_mfma_f32_16x16x32_bf16 v[132:135], v[100:103], v[32:35], 0
    v_mfma_f32_16x16x32_bf16 v[136:139], v[104:107], v[32:35], 0
    v_mfma_f32_16x16x32_bf16 v[140:143], v[108:111], v[32:35], 0
    v_perm_b32 v112, v242, v242, v4
    v_perm_b32 v113, v242, v242, v5
    v_perm_b32 v114, v242, v242, v6
    v_perm_b32 v115, v242, v242, v7
    v_perm_b32 v116, v242, v242, v8
    v_perm_b32 v117, v242, v242, v9
    v_perm_b32 v118, v242, v242, v10
    v_perm_b32 v119, v242, v242, v11
    v_perm_b32 v120, v243, v243, v4
    v_perm_b32 v121, v243, v243, v5
    v_perm_b32 v122, v243, v243, v6
    v_perm_b32 v123, v243, v243, v7
    v_perm_b32 v124, v243, v243, v8
    v_perm_b32 v125, v243, v243, v9
    v_perm_b32 v126, v243, v243, v10
    v_perm_b32 v127, v243, v243, v11
    s_waitcnt vmcnt(10)
    v_mfma_f32_16x16x32_bf16 v[128:131], v[112:115], v[36:39], v[128:131]
    v_mfma_f32_16x16x32_bf16 v[132:135], v[116:119], v[36:39], v[132:135]
    v_mfma_f32_16x16x32_bf16 v[136:139], v[120:123], v[36:39], v[136:139]
    v_mfma_f32_16x16x32_bf16 v[140:143], v[124:127], v[36:39], v[140:143]
    v_perm_b32 v96, v244, v244, v4
    v_perm_b32 v97, v244, v244, v5
    v_perm_b32 v98, v244, v244, v6
    v_perm_b32 v99, v244, v244, v7
    v_perm_b32 v100, v244, v244, v8
    v_perm_b32 v101, v244, v244, v9
    v_perm_b32 v102, v244, v244, v10
    v_perm_b32 v103, v244, v244, v11
    v_perm_b32 v104, v245, v245, v4
    v_perm_b32 v105, v245, v245, v5
    v_perm_b32 v106, v245, v245, v6
    v_perm_b32 v107, v245, v245, v7
    v_perm_b32 v108, v245, v245, v8
    v_perm_b32 v109, v245, v245, v9
    v_perm_b32 v110, v245, v245, v10
    v_perm_b32 v111, v245, v245, v11
    s_waitcnt vmcnt(9)
    v_mfma_f32_16x16x32_bf16 v[128:131], v[96:99], v[40:43], v[128:131]
    v_mfma_f32_16x16x32_bf16 v[132:135], v[100:103], v[40:43], v[132:135]
    v_mfma_f32_16x16x32_bf16 v[136:139], v[104:107], v[40:43], v[136:139]
    v_mfma_f32_16x16x32_bf16 v[140:143], v[108:111], v[40:43], v[140:143]
    v_perm_b32 v112, v246, v246, v4
    v_perm_b32 v113, v246, v246, v5
    v_perm_b32 v114, v246, v246, v6
    v_perm_b32 v115, v246, v246, v7
    v_perm_b32 v116, v246, v246, v8
    v_perm_b32 v117, v246, v246, v9
    v_perm_b32 v118, v246, v246, v10
    v_perm_b32 v119, v246, v246, v11
    v_perm_b32 v120, v247, v247, v4
    v_perm_b32 v121, v247, v247, v5
    v_perm_b32 v122, v247, v247, v6
    v_perm_b32 v123, v247, v247, v7
    v_perm_b32 v124, v247, v247, v8
    v_perm_b32 v125, v247, v247, v9
    v_perm_b32 v126, v247, v247, v10
    v_perm_b32 v127, v247, v247, v11
    s_waitcnt vmcnt(8)
    v_mfma_f32_16x16x32_bf16 v[128:131], v[112:115], v[44:47], v[128:131]
    v_mfma_f32_16x16x32_bf16 v[132:135], v[116:119], v[44:47], v[132:135]
    v_mfma_f32_16x16x32_bf16 v[136:139], v[120:123], v[44:47], v[136:139]
    v_mfma_f32_16x16x32_bf16 v[140:143], v[124:127], v[44:47], v[140:143]
    v_perm_b32 v96, v248, v248, v4
    v_perm_b32 v97, v248, v248, v5
    v_perm_b32 v98, v248, v248, v6
    v_perm_b32 v99, v248, v248, v7
    v_perm_b32 v100, v248, v248, v8
    v_perm_b32 v101, v248, v248, v9
    v_perm_b32 v102, v248, v248, v10
    v_perm_b32 v103, v248, v248, v11
    v_perm_b32 v104, v249, v249, v4
    v_perm_b32 v105, v249, v249, v5
    v_perm_b32 v106, v249, v249, v6
    v_perm_b32 v107, v249, v249, v7
    v_perm_b32 v108, v249, v249, v8
    v_perm_b32 v109, v249, v249, v9
    v_perm_b32 v110, v249, v249, v10
    v_perm_b32 v111, v249, v249, v11
    s_waitcnt vmcnt(7)
    v_mfma_f32_16x16x32_bf16 v[128:131], v[96:99], v[48:51], v[128:131]
    v_mfma_f32_16x16x32_bf16 v[132:135], v[100:103], v[48:51], v[132:135]
    v_mfma_f32_16x16x32_bf16 v[136:139], v[104:107], v[48:51], v[136:139]
    v_mfma_f32_16x16x32_bf16 v[140:143], v[108:111], v[48:51], v[140:143]
    v_perm_b32 v112, v250, v250, v4
    v_perm_b32 v113, v250, v250, v5
    v_perm_b32 v114, v250, v250, v6
    v_perm_b32 v115, v250, v250, v7
    v_perm_b32 v116, v250, v250, v8
    v_perm_b32 v117, v250, v250, v9
    v_perm_b32 v118, v250, v250, v10
    v_perm_b32 v119, v250, v250, v11
    v_perm_b32 v120, v251, v251, v4
    v_perm_b32 v121, v251, v251, v5
    v_perm_b32 v122, v251, v251, v6
    v_perm_b32 v123, v251, v251, v7
    v_perm_b32 v124, v251, v251, v8
    v_perm_b32 v125, v251, v251, v9
    v_perm_b32 v126, v251, v251, v10
    v_perm_b32 v127, v251, v251, v11
    s_waitcnt vmcnt(6)
    v_mfma_f32_16x16x32_bf16 v[128:131], v[112:115], v[52:55], v[128:131]
    v_mfma_f32_16x16x32_bf16 v[132:135], v[116:119], v[52:55], v[132:135]
    v_mfma_f32_16x16x32_bf16 v[136:139], v[120:123], v[52:55], v[136:139]
    v_mfma_f32_16x16x32_bf16 v[140:143], v[124:127], v[52:55], v[140:143]
    v_perm_b32 v96, v252, v252, v4
    v_perm_b32 v97, v252, v252, v5
    v_perm_b32 v98, v252, v252, v6
    v_perm_b32 v99, v252, v252, v7
    v_perm_b32 v100, v252, v252, v8
    v_perm_b32 v101, v252, v252, v9
    v_perm_b32 v102, v252, v252, v10
    v_perm_b32 v103, v252, v252, v11
    v_perm_b32 v104, v253, v253, v4
    v_perm_b32 v105, v253, v253, v5
    v_perm_b32 v106, v253, v253, v6
    v_perm_b32 v107, v253, v253, v7
    v_perm_b32 v108, v253, v253, v8
    v_perm_b32 v109, v253, v253, v9
    v_perm_b32 v110, v253, v253, v10
    v_perm_b32 v111, v253, v253, v11
    s_waitcnt vmcnt(5)
    v_mfma_f32_16x16x32_bf16 v[128:131], v[96:99], v[56:59], v[128:131]
    v_mfma_f32_16x16x32_bf16 v[132:135], v[100:103], v[56:59], v[132:135]
    v_mfma_f32_16x16x32_bf16 v[136:139], v[104:107], v[56:59], v[136:139]
    v_mfma_f32_16x16x32_bf16 v[140:143], v[108:111], v[56:59], v[140:143]
    v_perm_b32 v112, v254, v254, v4
    v_perm_b32 v113, v254, v254, v5
    v_perm_b32 v114, v254, v254, v6
    v_perm_b32 v115, v254, v254, v7
    v_perm_b32 v116, v254, v254, v8
    v_perm_b32 v117, v254, v254, v9
    v_perm_b32 v118, v254, v254, v10
    v_perm_b32 v119, v254, v254, v11
    v_perm_b32 v120, v255, v255, v4
    v_perm_b32 v121, v255, v255, v5
    v_perm_b32 v122, v255, v255, v6
    v_perm_b32 v123, v255, v255, v7
    v_perm_b32 v124, v255, v255, v8
    v_perm_b32 v125, v255, v255, v9
    v_perm_b32 v126, v255, v255, v10
    v_perm_b32 v127, v255, v255, v11
    s_waitcnt vmcnt(4)
    v_mfma_f32_16x16x32_bf16 v[128:131], v[112:115], v[60:63], v[128:131]
    v_mfma_f32_16x16x32_bf16 v[132:135], v[116:119], v[60:63], v[132:135]
    v_mfma_f32_16x16x32_bf16 v[136:139], v[120:123], v[60:63], v[136:139]
    v_mfma_f32_16x16x32_bf16 v[140:143], v[124:127], v[60:63], v[140:143]
    v_lshrrev_b32 v27, 1, v3
    v_lshlrev_b32 v27, 7, v27
    v_lshl_add_u32 v27, v2, 5, v27
    v_and_b32 v28, 1, v3
    v_lshl_add_u32 v27, v28, 4, v27
    v_cmp_gt_u32 vcc, 4, v2
    v_cndmask_b32 v27, v25, v27, vcc
    v_lshrrev_b32 v28, 2, v2
    s_nop 1
    v_cmp_eq_u32 vcc, 1, v28
    v_cndmask_b32 v128, v128, v132, vcc
    v_cndmask_b32 v129, v129, v133, vcc
    v_cndmask_b32 v130, v130, v134, vcc
    v_cndmask_b32 v131, v131, v135, vcc
    v_cmp_eq_u32 vcc, 2, v28
    v_cndmask_b32 v128, v128, v136, vcc
    v_cndmask_b32 v129, v129, v137, vcc
    v_cndmask_b32 v130, v130, v138, vcc
    v_cndmask_b32 v131, v131, v139, vcc
    v_cmp_eq_u32 vcc, 3, v28
    v_cndmask_b32 v128, v128, v140, vcc
    v_cndmask_b32 v129, v129, v141, vcc
    v_cndmask_b32 v130, v130, v142, vcc
    v_cndmask_b32 v131, v131, v143, vcc
    s_nop 1
    v_add_f32_dpp v128, v128, v128 row_ror:8 row_mask:0xf bank_mask:0xf
    v_add_f32_dpp v129, v129, v129 row_ror:8 row_mask:0xf bank_mask:0xf
    v_add_f32_dpp v130, v130, v130 row_ror:8 row_mask:0xf bank_mask:0xf
    v_add_f32_dpp v131, v131, v131 row_ror:8 row_mask:0xf bank_mask:0xf
    s_nop 1
    v_add_f32_dpp v128, v128, v128 row_ror:4 row_mask:0xf bank_mask:0xf
    v_add_f32_dpp v129, v129, v129 row_ror:4 row_mask:0xf bank_mask:0xf
    v_add_f32_dpp v130, v130, v130 row_ror:4 row_mask:0xf bank_mask:0xf
    v_add_f32_dpp v131, v131, v131 row_ror:4 row_mask:0xf bank_mask:0xf
    buffer_store_dwordx4 v[128:131], v27, s[40:43], s71 offen sc1
KWO:
    s_mov_b32 s70, 0
LS12:
    ds_read_b32 v31, v24 offset:44
    s_waitcnt lgkmcnt(0)
    v_readfirstlane_b32 s69, v31
    s_add_u32 s70, s70, 1
    s_cmp_ge_u32 s69, 4
    s_cbranch_scc1 LSD12
    s_cmp_lt_u32 s70, 400000
    s_cbranch_scc1 LS12
LSD12:
    s_add_u32 s64, s58, 0
    s_and_b32 s64, s64, 3
    s_lshl_b32 s64, s64, 12
    s_add_u32 s64, s64, s67
    buffer_load_dwordx4 v[160:163], v150, s[28:31], s64 offen offset:0
    buffer_load_dwordx4 v[164:167], v150, s[28:31], s64 offen offset:1024
    buffer_load_dwordx4 v[168:171], v150, s[28:31], s64 offen offset:2048
    buffer_load_dwordx4 v[172:175], v150, s[28:31], s64 offen offset:3072
    s_add_u32 s64, s58, 1
    s_and_b32 s64, s64, 3
    s_lshl_b32 s64, s64, 12
    s_add_u32 s64, s64, s67
    buffer_load_dwordx4 v[176:179], v150, s[28:31], s64 offen offset:0
    buffer_load_dwordx4 v[180:183], v150, s[28:31], s64 offen offset:1024
    buffer_load_dwordx4 v[184:187], v150, s[28:31], s64 offen offset:2048
    buffer_load_dwordx4 v[188:191], v150, s[28:31], s64 offen offset:3072
    s_add_u32 s64, s58, 2
    s_and_b32 s64, s64, 3
    s_lshl_b32 s64, s64, 12
    s_add_u32 s64, s64, s67
    buffer_load_dwordx4 v[192:195], v150, s[28:31], s64 offen offset:0
    buffer_load_dwordx4 v[196:199], v150, s[28:31], s64 offen offset:1024
    buffer_load_dwordx4 v[200:203], v150, s[28:31], s64 offen offset:2048
    buffer_load_dwordx4 v[204:207], v150, s[28:31], s64 offen offset:3072
    s_add_u32 s64, s58, 3
    s_and_b32 s64, s64, 3
    s_lshl_b32 s64, s64, 12
    s_add_u32 s64, s64, s67
    buffer_load_dwordx4 v[208:211], v150, s[28:31], s64 offen offset:0
    buffer_load_dwordx4 v[212:215], v150, s[28:31], s64 offen offset:1024
    buffer_load_dwordx4 v[216:219], v150, s[28:31], s64 offen offset:2048
    buffer_load_dwordx4 v[220:223], v150, s[28:31], s64 offen offset:3072
    v_lshrrev_b32 v12, 1, v3
    v_lshlrev_b32 v12, 5, v12
    v_lshrrev_b32 v13, 1, v2
    v_add_u32 v12, v12, v13
    s_lshl_b32 s64, s66, 3
    v_add_u32 v12, s64, v12
    v_and_b32 v13, 1, v2
    v_lshlrev_b32 v13, 5, v13
    v_and_b32 v14, 1, v3
    v_lshl_add_u32 v13, v14, 4, v13
    v_lshl_add_u32 v14, v12, 14, v13
    s_lshl_b32 s64, s2, 6
    s_add_u32 s64, s64, 2359296
    v_add_u32 v21, s64, v14
    v_lshlrev_b32 v26, 4, v1
    s_lshl_b32 s65, s66, 12
    s_add_u32 s65, s65, 135168
    v_add_u32 v26, s65, v26
    v_mov_b32 v117, v25
    s_mov_b32 s95, 0
    s_mov_b32 s70, 0
LS13:
    ds_read_b32 v31, v24 offset:24
    s_waitcnt lgkmcnt(0)
    v_readfirstlane_b32 s69, v31
    s_add_u32 s70, s70, 1
    s_cmp_ge_u32 s69, 4
    s_cbranch_scc1 LSD13
    s_cmp_lt_u32 s70, 400000
    s_cbranch_scc1 LS13
LSD13:
    s_waitcnt vmcnt(16)
    ds_write_b128 v26, v[224:227] offset:0
    ds_write_b128 v26, v[228:231] offset:1024
    ds_write_b128 v26, v[232:235] offset:2048
    ds_write_b128 v26, v[236:239] offset:3072
    s_cmp_lg_u32 s62, 6
    s_cbranch_scc1 FLGD
    s_movk_i32 s64, 4096
    v_lshlrev_b32 v15, 4, v1
    s_mov_b32 s70, 0
FLG:
    v_xor_b32 v16, s63, v16
    v_xor_b32 v17, s63, v17
    v_xor_b32 v18, s63, v18
    v_xor_b32 v19, s63, v19
    v_or3_b32 v16, v16, v17, v18
    v_or_b32 v16, v16, v19
    v_cmp_ne_u32 vcc, 0, v16
    s_add_u32 s70, s70, 1
    s_cbranch_vccz FLGD
    buffer_load_dwordx4 v[16:19], v15, s[40:43], s64 offen sc1
    s_waitcnt vmcnt(0)
    s_cmp_lt_u32 s70, 400000
    s_cbranch_scc1 FLG
FLGD:
    s_waitcnt lgkmcnt(0)
JOIN:
    v_and_b32 v12, 1, v3
    v_lshlrev_b32 v13, 5, v12
    v_lshrrev_b32 v14, 1, v3
    v_lshl_add_u32 v13, v14, 2, v13
    v_lshrrev_b32 v14, 2, v2
    v_add_u32 v13, v13, v14
    v_and_b32 v14, 2, v14
    v_lshl_add_u32 v14, v12, 2, v14
    v_bfe_u32 v15, v2, 1, 1
    v_or_b32 v14, v14, v15
    v_and_b32 v15, 1, v2
    v_lshlrev_b32 v15, 3, v15
    v_lshl_add_u32 v13, v13, 7, v15
    s_and_b32 s64, s62, 1
    s_lshl_b32 s64, s64, 13
    s_add_u32 s64, s64, 135168
    v_add_u32 v13, s64, v13
    v_xor_b32 v15, 0, v14
    v_lshl_add_u32 v26, v15, 4, v13
    v_xor_b32 v15, 2, v14
    v_lshl_add_u32 v27, v15, 4, v13
    v_xor_b32 v15, 4, v14
    v_lshl_add_u32 v28, v15, 4, v13
    v_xor_b32 v15, 6, v14
    v_lshl_add_u32 v29, v15, 4, v13
    s_lshl_b32 s64, s59, 2
    s_add_u32 s64, s64, s58
    s_lshl_b32 s64, s64, 14
    s_lshr_b32 s65, s62, 1
    s_lshl_b32 s66, s65, 12
    s_add_u32 s64, s64, s66
    s_and_b32 s66, s62, 1
    s_lshl_b32 s66, s66, 7
    s_add_u32 s64, s64, s66
    s_add_u32 s64, s64, 262144
    v_lshlrev_b32 v30, 8, v2
    v_lshl_add_u32 v30, v3, 4, v30
    v_add_u32 v30, s64, v30
    s_lshl_b32 s64, s59, 9
    s_add_u32 s64, s64, 163840
    s_lshl_b32 s66, s65, 7
    s_add_u32 s66, s66, s64
    s_xor_b32 s65, s65, 1
    s_lshl_b32 s65, s65, 7
    s_add_u32 s65, s65, s64
    v_lshlrev_b32 v12, 5, v3
    v_add_u32 v22, s65, v12
    v_add_u32 v20, s66, v12
    s_barrier
    ds_read_b64_tr_b16 v[32:33], v26 offset:0
    ds_read_b64_tr_b16 v[34:35], v26 offset:2048
    ds_read_b64_tr_b16 v[36:37], v26 offset:1024
    ds_read_b64_tr_b16 v[38:39], v26 offset:3072
    ds_read_b64_tr_b16 v[40:41], v27 offset:0
    ds_read_b64_tr_b16 v[42:43], v27 offset:2048
    ds_read_b64_tr_b16 v[44:45], v27 offset:1024
    ds_read_b64_tr_b16 v[46:47], v27 offset:3072
    s_waitcnt lgkmcnt(4)
    ds_read_b64_tr_b16 v[48:49], v28 offset:0
    ds_read_b64_tr_b16 v[50:51], v28 offset:2048
    ds_read_b64_tr_b16 v[52:53], v28 offset:1024
    ds_read_b64_tr_b16 v[54:55], v28 offset:3072
    ds_read_b64_tr_b16 v[56:57], v29 offset:0
    ds_read_b64_tr_b16 v[58:59], v29 offset:2048
    ds_read_b64_tr_b16 v[60:61], v29 offset:1024
    ds_read_b64_tr_b16 v[62:63], v29 offset:3072
    s_mov_b32 s70, 0
POLL14:
    buffer_load_dwordx4 v[64:67], v30, s[40:43], 0 offen sc1
    buffer_load_dwordx4 v[68:71], v30, s[40:43], 0 offen offset:64 sc1
    buffer_load_dwordx4 v[72:75], v20, s[40:43], 0 offen sc1
    buffer_load_dwordx4 v[76:79], v20, s[40:43], 0 offen offset:16 sc1
    buffer_load_dwordx4 v[80:83], v22, s[40:43], 0 offen sc1
    buffer_load_dwordx4 v[84:87], v22, s[40:43], 0 offen offset:16 sc1
    buffer_load_dwordx4 v[112:115], v117, s[40:43], 0 offen sc1
POLLW14:
    s_waitcnt vmcnt(0)
POLLX14:
    v_max_u32 v16, v64, v65
    v_max3_u32 v16, v16, v66, v67
    v_max3_u32 v16, v16, v68, v69
    v_max3_u32 v16, v16, v70, v71
    v_max3_u32 v16, v16, v72, v73
    v_max3_u32 v16, v16, v74, v75
    v_max3_u32 v16, v16, v76, v77
    v_max3_u32 v16, v16, v78, v79
    v_max3_u32 v16, v16, v80, v81
    v_max3_u32 v16, v16, v82, v83
    v_max3_u32 v16, v16, v84, v85
    v_max3_u32 v16, v16, v86, v87
    v_max3_u32 v16, v16, v112, v113
    v_max3_u32 v16, v16, v114, v115
    v_cmp_eq_u32 vcc, -1, v16
    s_add_u32 s70, s70, 1
    s_cbranch_vccz POLLD14
    s_mov_b64 exec, vcc
    s_cmp_lt_u32 s70, 400000
    s_cbranch_scc1 POLL14
POLLD14:
    s_mov_b64 exec, -1
    s_waitcnt lgkmcnt(0)
    v_mfma_f32_16x16x32_bf16 v[96:99], v[64:67], v[32:35], 0
    v_mfma_f32_16x16x32_bf16 v[100:103], v[64:67], v[40:43], 0
    v_mfma_f32_16x16x32_bf16 v[104:107], v[64:67], v[48:51], 0
    v_mfma_f32_16x16x32_bf16 v[108:111], v[64:67], v[56:59], 0
    v_mfma_f32_16x16x32_bf16 v[96:99], v[68:71], v[36:39], v[96:99]
    v_mfma_f32_16x16x32_bf16 v[100:103], v[68:71], v[44:47], v[100:103]
    v_mfma_f32_16x16x32_bf16 v[104:107], v[68:71], v[52:55], v[104:107]
    v_mfma_f32_16x16x32_bf16 v[108:111], v[68:71], v[60:63], v[108:111]
    v_max3_f32 v12, v72, v74, v76
    v_max3_f32 v12, v12, v78, v80
    v_max3_f32 v12, v12, v82, v84
    v_max_f32 v12, v12, v86
    v_mov_b32 v13, v12
    s_nop 1
    v_permlane16_swap_b32 v12, v13
    s_nop 1
    v_max_f32 v12, v12, v13
    v_mov_b32 v13, v12
    s_nop 1
    v_permlane32_swap_b32 v12, v13
    s_nop 1
    v_max_f32 v12, v12, v13
    v_sub_f32 v72, v72, v12
    v_sub_f32 v74, v74, v12
    v_sub_f32 v76, v76, v12
    v_sub_f32 v78, v78, v12
    v_sub_f32 v80, v80, v12
    v_sub_f32 v82, v82, v12
    v_sub_f32 v84, v84, v12
    v_sub_f32 v86, v86, v12
    v_mul_f32 v72, 0x3fb8aa3b, v72
    v_mul_f32 v74, 0x3fb8aa3b, v74
    v_mul_f32 v76, 0x3fb8aa3b, v76
    v_mul_f32 v78, 0x3fb8aa3b, v78
    v_mul_f32 v80, 0x3fb8aa3b, v80
    v_mul_f32 v82, 0x3fb8aa3b, v82
    v_mul_f32 v84, 0x3fb8aa3b, v84
    v_mul_f32 v86, 0x3fb8aa3b, v86
    v_exp_f32 v72, v72
    v_exp_f32 v74, v74
    v_exp_f32 v76, v76
    v_exp_f32 v78, v78
    v_exp_f32 v80, v80
    v_exp_f32 v82, v82
    v_exp_f32 v84, v84
    v_exp_f32 v86, v86
    s_nop 0
    v_mul_f32 v13, v72, v73
    v_mul_f32 v14, v74, v75
    v_fmac_f32 v13, v76, v77
    v_fmac_f32 v14, v78, v79
    v_fmac_f32 v13, v80, v81
    v_fmac_f32 v14, v82, v83
    v_fmac_f32 v13, v84, v85
    v_fmac_f32 v14, v86, v87
    v_mul_f32 v88, v96, v72
    v_mul_f32 v89, v100, v72
    v_mul_f32 v90, v104, v72
    v_mul_f32 v91, v108, v72
    v_add_f32 v13, v13, v14
    v_fmac_f32 v88, v97, v74
    v_fmac_f32 v89, v101, v74
    v_fmac_f32 v90, v105, v74
    v_fmac_f32 v91, v109, v74
    v_fmac_f32 v88, v98, v76
    v_fmac_f32 v89, v102, v76
    v_fmac_f32 v90, v106, v76
    v_fmac_f32 v91, v110, v76
    v_fmac_f32 v88, v99, v78
    v_fmac_f32 v89, v103, v78
    v_fmac_f32 v90, v107, v78
    v_fmac_f32 v91, v111, v78
    v_mov_b32 v14, v13
    s_nop 1
    v_permlane32_swap_b32 v13, v14
    v_permlane32_swap_b32 v88, v90
    v_permlane32_swap_b32 v89, v91
    s_nop 1
    v_add_f32 v13, v13, v14
    v_add_f32 v88, v88, v90
    v_add_f32 v89, v89, v91
    v_mov_b32 v14, v13
    s_nop 1
    v_permlane16_swap_b32 v13, v14
    v_permlane16_swap_b32 v88, v89
    s_nop 1
    v_add_f32 v13, v13, v14
    v_add_f32 v88, v88, v89
    v_rcp_f32 v13, v13
    v_lshlrev_b32 v26, 2, v0
    v_add_u32 v26, 159168, v26
    v_mul_f32 v88, v88, v13
    ds_write_b32 v26, v88
    v_lshrrev_b32 v27, 5, v1
    v_lshlrev_b32 v27, 10, v27
    v_and_b32 v28, 31, v1
    v_lshl_add_u32 v27, v28, 3, v27
    v_add_u32 v27, 159168, v27
    v_lshlrev_b32 v28, 2, v1
    v_add_u32 v28, 161216, v28
    v_lshrrev_b32 v29, 3, v2
    v_lshlrev_b32 v29, 7, v29
    v_lshl_add_u32 v29, v3, 5, v29
    v_add_u32 v29, 161216, v29
    s_add_u32 s64, s58, 0
    s_and_b32 s64, s64, 3
    s_lshl_b32 s64, s64, 3
    v_add_u32 v72, s64, v29
    s_add_u32 s64, s58, 1
    s_and_b32 s64, s64, 3
    s_lshl_b32 s64, s64, 3
    v_add_u32 v73, s64, v29
    s_add_u32 s64, s58, 2
    s_and_b32 s64, s64, 3
    s_lshl_b32 s64, s64, 3
    v_add_u32 v74, s64, v29
    s_add_u32 s64, s58, 3
    s_and_b32 s64, s64, 3
    s_lshl_b32 s64, s64, 3
    v_add_u32 v75, s64, v29
    s_waitcnt lgkmcnt(0)
    s_barrier
    s_cmp_lg_u32 s95, 0
    s_cbranch_scc1 FFN2
    s_cmp_lt_u32 s62, 4
    s_cbranch_scc1 FINAL
    ds_read_b64 v[64:65], v27 offset:0
    ds_read_b64 v[66:67], v27 offset:256
    ds_read_b64 v[68:69], v27 offset:512
    ds_read_b64 v[70:71], v27 offset:768
    s_waitcnt lgkmcnt(0)
    v_add_f32 v64, v64, v66
    v_add_f32 v68, v68, v70
    v_add_f32 v65, v65, v67
    v_add_f32 v69, v69, v71
    v_add_f32 v64, v64, v68
    v_add_f32 v65, v65, v69
    v_cvt_pk_bf16_f32 v64, v64, v65
    ds_write_b32 v28, v64
    ds_read_b64 v[12:13], v72
    ds_read_b64 v[14:15], v73
    ds_read_b64 v[16:17], v74
    ds_read_b64 v[18:19], v75
    s_waitcnt lgkmcnt(3)
    v_perm_b32 v32, v12, v12, v4
    v_perm_b32 v33, v12, v12, v5
    v_perm_b32 v34, v12, v12, v6
    v_perm_b32 v35, v12, v12, v7
    v_perm_b32 v36, v12, v12, v8
    v_perm_b32 v37, v12, v12, v9
    v_perm_b32 v38, v12, v12, v10
    v_perm_b32 v39, v12, v12, v11
    v_mfma_f32_16x16x32_bf16 v[96:99], v[32:35], v[160:163], 0
    v_perm_b32 v40, v13, v13, v4
    v_perm_b32 v41, v13, v13, v5
    v_perm_b32 v42, v13, v13, v6
    v_perm_b32 v43, v13, v13, v7
    v_mfma_f32_16x16x32_bf16 v[100:103], v[36:39], v[164:167], 0
    v_perm_b32 v44, v13, v13, v8
    v_perm_b32 v45, v13, v13, v9
    v_perm_b32 v46, v13, v13, v10
    v_perm_b32 v47, v13, v13, v11
    v_mfma_f32_16x16x32_bf16 v[96:99], v[40:43], v[168:171], v[96:99]
    s_waitcnt lgkmcnt(2)
    v_perm_b32 v48, v14, v14, v4
    v_perm_b32 v49, v14, v14, v5
    v_perm_b32 v50, v14, v14, v6
    v_perm_b32 v51, v14, v14, v7
    v_mfma_f32_16x16x32_bf16 v[100:103], v[44:47], v[172:175], v[100:103]
    v_perm_b32 v52, v14, v14, v8
    v_perm_b32 v53, v14, v14, v9
    v_perm_b32 v54, v14, v14, v10
    v_perm_b32 v55, v14, v14, v11
    v_mfma_f32_16x16x32_bf16 v[96:99], v[48:51], v[176:179], v[96:99]
    v_perm_b32 v56, v15, v15, v4
    v_perm_b32 v57, v15, v15, v5
    v_perm_b32 v58, v15, v15, v6
    v_perm_b32 v59, v15, v15, v7
    v_mfma_f32_16x16x32_bf16 v[100:103], v[52:55], v[180:183], v[100:103]
    v_perm_b32 v60, v15, v15, v8
    v_perm_b32 v61, v15, v15, v9
    v_perm_b32 v62, v15, v15, v10
    v_perm_b32 v63, v15, v15, v11
    v_mfma_f32_16x16x32_bf16 v[96:99], v[56:59], v[184:187], v[96:99]
    s_waitcnt lgkmcnt(1)
    v_perm_b32 v64, v16, v16, v4
    v_perm_b32 v65, v16, v16, v5
    v_perm_b32 v66, v16, v16, v6
    v_perm_b32 v67, v16, v16, v7
    v_mfma_f32_16x16x32_bf16 v[100:103], v[60:63], v[188:191], v[100:103]
    v_perm_b32 v68, v16, v16, v8
    v_perm_b32 v69, v16, v16, v9
    v_perm_b32 v70, v16, v16, v10
    v_perm_b32 v71, v16, v16, v11
    v_mfma_f32_16x16x32_bf16 v[96:99], v[64:67], v[192:195], v[96:99]
    v_perm_b32 v72, v17, v17, v4
    v_perm_b32 v73, v17, v17, v5
    v_perm_b32 v74, v17, v17, v6
    v_perm_b32 v75, v17, v17, v7
    v_mfma_f32_16x16x32_bf16 v[100:103], v[68:71], v[196:199], v[100:103]
    v_perm_b32 v76, v17, v17, v8
    v_perm_b32 v77, v17, v17, v9
    v_perm_b32 v78, v17, v17, v10
    v_perm_b32 v79, v17, v17, v11
    v_mfma_f32_16x16x32_bf16 v[96:99], v[72:75], v[200:203], v[96:99]
    s_waitcnt lgkmcnt(0)
    v_perm_b32 v80, v18, v18, v4
    v_perm_b32 v81, v18, v18, v5
    v_perm_b32 v82, v18, v18, v6
    v_perm_b32 v83, v18, v18, v7
    v_mfma_f32_16x16x32_bf16 v[100:103], v[76:79], v[204:207], v[100:103]
    v_perm_b32 v84, v18, v18, v8
    v_perm_b32 v85, v18, v18, v9
    v_perm_b32 v86, v18, v18, v10
    v_perm_b32 v87, v18, v18, v11
    v_mfma_f32_16x16x32_bf16 v[96:99], v[80:83], v[208:211], v[96:99]
    v_perm_b32 v88, v19, v19, v4
    v_perm_b32 v89, v19, v19, v5
    v_perm_b32 v90, v19, v19, v6
    v_perm_b32 v91, v19, v19, v7
    v_mfma_f32_16x16x32_bf16 v[100:103], v[84:87], v[212:215], v[100:103]
    v_perm_b32 v92, v19, v19, v8
    v_perm_b32 v93, v19, v19, v9
    v_perm_b32 v94, v19, v19, v10
    v_perm_b32 v95, v19, v19, v11
    v_mfma_f32_16x16x32_bf16 v[96:99], v[88:91], v[216:219], v[96:99]
    s_nop 1
    v_mfma_f32_16x16x32_bf16 v[100:103], v[92:95], v[220:223], v[100:103]
    s_nop 7
    s_nop 0
    v_add_f32 v96, v96, v100
    v_add_f32 v97, v97, v101
    v_add_f32 v98, v98, v102
    v_add_f32 v99, v99, v103
    buffer_store_dwordx4 v[96:99], v21, s[40:43], 0 offen sc1
    s_branch FINAL
FFN2:
    v_permlane32_swap_b32 v112, v114
    v_permlane32_swap_b32 v113, v115
    s_nop 1
    v_add_f32 v112, v112, v114
    v_add_f32 v113, v113, v115
    s_nop 1
    v_permlane16_swap_b32 v112, v113
    s_nop 1
    v_add_f32 v112, v112, v113
    v_cvt_pk_bf16_f32 v112, v112, v112
    v_lshlrev_b32 v112, 16, v112
    v_lshlrev_b32 v116, 16, v116
    v_add_f32 v112, v112, v116
    v_cvt_pk_bf16_f32 v112, v112, v112
    v_lshlrev_b32 v112, 16, v112
    v_mul_f32 v113, v112, v112
    v_mul_f32 v113, v113, v112
    v_mov_b32 v114, 0x3d372713
    v_fma_f32 v113, v113, v114, v112
    v_mul_f32 v113, 0xc0135761, v113
    v_exp_f32 v113, v113
    s_nop 0
    v_add_f32 v113, 1.0, v113
    v_rcp_f32 v113, v113
    s_nop 0
    v_mul_f32 v112, v112, v113
    v_cvt_pk_bf16_f32 v112, v112, v112
    ds_write_b16 v118, v112
    ds_read_b128 v[112:115], v119
    s_waitcnt lgkmcnt(0)
    v_perm_b32 v192, v112, v112, v4
    v_perm_b32 v193, v112, v112, v5
    v_perm_b32 v194, v112, v112, v6
    v_perm_b32 v195, v112, v112, v7
    v_perm_b32 v196, v112, v112, v8
    v_perm_b32 v197, v112, v112, v9
    v_perm_b32 v198, v112, v112, v10
    v_perm_b32 v199, v112, v112, v11
    v_perm_b32 v200, v113, v113, v4
    v_perm_b32 v201, v113, v113, v5
    v_perm_b32 v202, v113, v113, v6
    v_perm_b32 v203, v113, v113, v7
    v_perm_b32 v204, v113, v113, v8
    v_perm_b32 v205, v113, v113, v9
    v_perm_b32 v206, v113, v113, v10
    v_perm_b32 v207, v113, v113, v11
    v_perm_b32 v208, v114, v114, v4
    v_perm_b32 v209, v114, v114, v5
    v_perm_b32 v210, v114, v114, v6
    v_perm_b32 v211, v114, v114, v7
    v_perm_b32 v212, v114, v114, v8
    v_perm_b32 v213, v114, v114, v9
    v_perm_b32 v214, v114, v114, v10
    v_perm_b32 v215, v114, v114, v11
    v_perm_b32 v216, v115, v115, v4
    v_perm_b32 v217, v115, v115, v5
    v_perm_b32 v218, v115, v115, v6
    v_perm_b32 v219, v115, v115, v7
    v_perm_b32 v220, v115, v115, v8
    v_perm_b32 v221, v115, v115, v9
    v_perm_b32 v222, v115, v115, v10
    v_perm_b32 v223, v115, v115, v11
    s_nop 1
    v_mfma_f32_16x16x32_bf16 v[128:131], v[192:195], v[160:163], 0
    v_mfma_f32_16x16x32_bf16 v[132:135], v[196:199], v[164:167], 0
    v_mfma_f32_16x16x32_bf16 v[128:131], v[200:203], v[168:171], v[128:131]
    v_mfma_f32_16x16x32_bf16 v[132:135], v[204:207], v[172:175], v[132:135]
    v_mfma_f32_16x16x32_bf16 v[128:131], v[208:211], v[176:179], v[128:131]
    v_mfma_f32_16x16x32_bf16 v[132:135], v[212:215], v[180:183], v[132:135]
    v_mfma_f32_16x16x32_bf16 v[128:131], v[216:219], v[184:187], v[128:131]
    v_mfma_f32_16x16x32_bf16 v[132:135], v[220:223], v[188:191], v[132:135]
    s_nop 7
    s_nop 0
    v_add_f32 v128, v128, v132
    v_add_f32 v129, v129, v133
    v_add_f32 v130, v130, v134
    v_add_f32 v131, v131, v135
    buffer_store_dwordx4 v[128:131], v120, s[40:43], 0 offen sc1
FINAL:
    s_cmp_lt_u32 s2, 192
    s_cbranch_scc1 DONE
    s_sub_u32 s71, s2, 192
    s_lshl_b32 s64, s71, 14
    s_add_u32 s64, s64, 2359296
    v_lshlrev_b32 v26, 4, v0
    v_add_u32 v27, s64, v26
    v_add_u32 v28, 8192, v27
    s_lshl_b32 s64, s71, 12
    s_add_u32 s64, s64, 3407872
    v_add_u32 v29, s64, v26
    v_cmp_gt_u32 vcc, 172, v0
    v_cndmask_b32 v29, v25, v29, vcc
    s_lshl_b32 s64, s71, 5
    v_lshlrev_b32 v30, 1, v2
    buffer_load_ushort v40, v30, s[8:11], s64 offen
    s_and_b32 s65, s71, 31
    s_lshl_b32 s65, s65, 5
    buffer_load_ushort v41, v30, s[52:55], s65 offen
    v_lshrrev_b32 v26, 1, v3
    v_lshlrev_b32 v26, 9, v26
    v_and_b32 v12, 3, v2
    v_lshl_add_u32 v26, v12, 7, v26
    v_and_b32 v12, 1, v3
    v_lshl_add_u32 v26, v12, 6, v26
    s_lshl_b32 s64, s62, 2
    s_add_u32 s64, s64, 161472
    v_add_u32 v26, s64, v26
    v_lshlrev_b32 v20, 5, v2
    v_add_u32 v20, 161472, v20
    s_mov_b32 s70, 0
POLL15:
    buffer_load_dwordx4 v[64:67], v27, s[40:43], 0 offen sc1
    buffer_load_dwordx4 v[68:71], v28, s[40:43], 0 offen sc1
    buffer_load_dwordx4 v[72:75], v29, s[40:43], 0 offen sc1
POLLW15:
    s_waitcnt vmcnt(0)
POLLX15:
    v_max_u32 v16, v64, v65
    v_max3_u32 v16, v16, v66, v67
    v_max3_u32 v16, v16, v68, v69
    v_max3_u32 v16, v16, v70, v71
    v_max3_u32 v16, v16, v72, v73
    v_max3_u32 v16, v16, v74, v75
    v_cmp_eq_u32 vcc, -1, v16
    s_add_u32 s70, s70, 1
    s_cbranch_vccz POLLD15
    s_mov_b64 exec, vcc
    s_cmp_lt_u32 s70, 400000
    s_cbranch_scc1 POLL15
POLLD15:
    s_mov_b64 exec, -1
    v_add_f32 v64, v64, v68
    v_add_f32 v65, v65, v69
    v_add_f32 v66, v66, v70
    v_add_f32 v67, v67, v71
    s_nop 1
    v_add_f32_dpp v64, v64, v64 row_ror:8 row_mask:0xf bank_mask:0xf
    v_add_f32_dpp v65, v65, v65 row_ror:8 row_mask:0xf bank_mask:0xf
    v_add_f32_dpp v66, v66, v66 row_ror:8 row_mask:0xf bank_mask:0xf
    v_add_f32_dpp v67, v67, v67 row_ror:8 row_mask:0xf bank_mask:0xf
    v_add_f32_dpp v72, v72, v72 row_ror:8 row_mask:0xf bank_mask:0xf
    v_add_f32_dpp v73, v73, v73 row_ror:8 row_mask:0xf bank_mask:0xf
    v_add_f32_dpp v74, v74, v74 row_ror:8 row_mask:0xf bank_mask:0xf
    v_add_f32_dpp v75, v75, v75 row_ror:8 row_mask:0xf bank_mask:0xf
    s_nop 1
    v_add_f32_dpp v64, v64, v64 row_ror:4 row_mask:0xf bank_mask:0xf
    v_add_f32_dpp v65, v65, v65 row_ror:4 row_mask:0xf bank_mask:0xf
    v_add_f32_dpp v66, v66, v66 row_ror:4 row_mask:0xf bank_mask:0xf
    v_add_f32_dpp v67, v67, v67 row_ror:4 row_mask:0xf bank_mask:0xf
    v_add_f32_dpp v72, v72, v72 row_ror:4 row_mask:0xf bank_mask:0xf
    v_add_f32_dpp v73, v73, v73 row_ror:4 row_mask:0xf bank_mask:0xf
    v_add_f32_dpp v74, v74, v74 row_ror:4 row_mask:0xf bank_mask:0xf
    v_add_f32_dpp v75, v75, v75 row_ror:4 row_mask:0xf bank_mask:0xf
    s_nop 1
    v_permlane32_swap_b32 v64, v72
    v_permlane32_swap_b32 v65, v73
    v_permlane32_swap_b32 v66, v74
    v_permlane32_swap_b32 v67, v75
    s_nop 1
    v_add_f32 v64, v64, v72
    v_add_f32 v65, v65, v73
    v_add_f32 v66, v66, v74
    v_add_f32 v67, v67, v75
    s_nop 1
    v_permlane16_swap_b32 v64, v66
    v_permlane16_swap_b32 v65, v67
    s_nop 1
    v_add_f32 v64, v64, v66
    v_add_f32 v65, v65, v67
    ds_write_b32 v26, v64
    ds_write_b32 v26, v65 offset:32
    s_waitcnt lgkmcnt(0)
    s_barrier
    s_cmp_lg_u32 s62, 7
    s_cbranch_scc1 DONE
    ds_read_b128 v[64:67], v20
    ds_read_b128 v[68:71], v20 offset:16
    ds_read_b128 v[72:75], v20 offset:512
    ds_read_b128 v[76:79], v20 offset:528
    s_waitcnt lgkmcnt(0)
    v_add_f32 v64, v64, v68
    v_add_f32 v65, v65, v69
    v_add_f32 v66, v66, v70
    v_add_f32 v67, v67, v71
    v_add_f32 v72, v72, v76
    v_add_f32 v73, v73, v77
    v_add_f32 v74, v74, v78
    v_add_f32 v75, v75, v79
    v_add_f32 v64, v64, v66
    v_add_f32 v65, v65, v67
    v_add_f32 v72, v72, v74
    v_add_f32 v73, v73, v75
    v_add_f32 v64, v64, v65
    v_add_f32 v72, v72, v73
    v_cvt_pk_bf16_f32 v12, v64, v72
    v_lshlrev_b32 v64, 16, v12
    v_and_b32 v72, 0xffff0000, v12
    v_lshlrev_b32 v40, 16, v40
    v_lshlrev_b32 v41, 16, v41
    v_add_f32 v72, v72, v41
    v_cvt_pk_bf16_f32 v12, v72, v72
    v_lshlrev_b32 v72, 16, v12
    v_mul_f32 v13, 0xbfb8aa3b, v72
    v_exp_f32 v13, v13
    s_nop 0
    v_add_f32 v13, 1.0, v13
    v_rcp_f32 v13, v13
    s_nop 0
    v_mul_f32 v72, v72, v13
    v_cvt_pk_bf16_f32 v12, v72, v72
    v_lshlrev_b32 v72, 16, v12
    v_mul_f32 v64, v64, v72
    v_cvt_pk_bf16_f32 v12, v64, v64
    v_lshlrev_b32 v64, 16, v12
    v_add_f32 v64, v64, v40
    v_cvt_pk_bf16_f32 v12, v64, v64
    v_cmp_gt_u32 vcc, 16, v1
    v_cndmask_b32 v30, v25, v30, vcc
    s_lshl_b32 s64, s71, 5
    buffer_store_short v12, v30, s[44:47], s64 offen
    s_cmp_lg_u32 s71, 0
    s_cbranch_scc1 DONE
    v_mov_b32 v13, s63
    v_mov_b32 v14, 0
    v_cmp_eq_u32 vcc, 0, v1
    v_cndmask_b32 v14, v25, v14, vcc
    buffer_store_dword v13, v14, s[40:43], 0 offen sc1
DONE:
END:
s_endpgm
.section .rodata,"a"
.p2align 6
.amdhsa_kernel recurrent_scan__compressed_kv_cla__dense_activation_gelu__decode_kernel
  .amdhsa_next_free_vgpr 256
  .amdhsa_next_free_sgpr 102
  .amdhsa_accum_offset 256
  .amdhsa_group_segment_fixed_size 0
  .amdhsa_kernarg_size 112
  .amdhsa_user_sgpr_count 2
  .amdhsa_user_sgpr_kernarg_segment_ptr 1
  .amdhsa_system_sgpr_workgroup_id_x 1
.end_amdhsa_kernel
```
